```python
import torch

def _softmax(x, axis=-1):
    return torch.softmax(x, dim=axis)

def _gelu(x):
    return torch.nn.functional.gelu(x, approximate='tanh')

def _silu(x):
    return torch.nn.functional.silu(x)

def _sigmoid(x):
    return torch.sigmoid(x)

def _layernorm(x, axis=-1, eps=1e-05):
    m = x.mean(dim=axis, keepdim=True)
    v = x.var(dim=axis, keepdim=True, unbiased=False)
    return (x - m) / torch.sqrt(v + eps)

def _scatter_add(tgt, idx, src, axis=0):
    return tgt.clone().index_add_(axis, idx, src)

def _segment_sum(src, seg, n):
    out = torch.zeros((n,) + src.shape[1:], dtype=src.dtype)
    return out.index_add_(0, seg, src)

def _pad(x, pw):
    flat = tuple((v for pair in reversed(pw) for v in pair))
    return torch.nn.functional.pad(x, flat)
kernel_name = 'adaLN_cond__mha_block_cached__glu_gated_swiglu__decode'

def setup_inputs():

    _w = lambda a: (lambda t: t.to(torch.bfloat16) if t.is_floating_point() else t)(torch.as_tensor(a))

    def _A_setup():
        B, Sq, D = (1, 1, 512)
        H, Sk, Dh = (32, 4096, 128)
        return {'x': _w((lambda *s: torch.randn(*s, dtype=torch.bfloat16) * 0.05)(B, Sq, D)), 'k_cache': _w((lambda *s: torch.randn(*s, dtype=torch.bfloat16) * 3.2)(B, H, Sk, Dh)), 'v_cache': _w((lambda *s: torch.randn(*s, dtype=torch.bfloat16) * 3.2)(B, H, Sk, Dh)), 'wq': _w((lambda *s: torch.randn(*s, dtype=torch.bfloat16) * 3.2)(D, H * Dh) * D ** (-0.5)), 'wo': _w((lambda *s: torch.randn(*s, dtype=torch.bfloat16) * 3.2)(H * Dh, D) * (H * Dh) ** (-0.5))}
    _A_in = _A_setup()

    def _B_setup():
        B, S, D, F = (1, 1, 512, 1376)
        return {'x': _w((lambda *s: torch.randn(*s, dtype=torch.bfloat16) * 0.05)(B, S, D)), 'w1': _w((lambda *s: torch.randn(*s, dtype=torch.bfloat16) * 1.6)(D, F) * (2.0 / D) ** 0.5), 'w3': _w((lambda *s: torch.randn(*s, dtype=torch.bfloat16) * 1.6)(D, F) * (2.0 / D) ** 0.5), 'w2': _w((lambda *s: torch.randn(*s, dtype=torch.bfloat16) * 1.6)(F, D) * (2.0 / F) ** 0.5)}
    _B_in = _B_setup()
    return {'A_x': _A_in['x'], 'A_k_cache': _A_in['k_cache'], 'A_v_cache': _A_in['v_cache'], 'A_wq': _A_in['wq'], 'A_wo': _A_in['wo'], 'B_x': _B_in['x'], 'B_w1': _B_in['w1'], 'B_w3': _B_in['w3'], 'B_w2': _B_in['w2'], 'c': _w((lambda *s: torch.randn(*s, dtype=torch.bfloat16) * 0.2)(1, 512) * 8.0), 'w_mod': _w((lambda *s: torch.randn(*s, dtype=torch.bfloat16) * 0.2)(512, 6 * 512) * 512 ** (-0.5) * 8.0)}

def reference(A_x, A_k_cache, A_v_cache, A_wq, A_wo, B_x, B_w1, B_w3, B_w2, c, w_mod):

    def _A_ref(x, k_cache, v_cache, wq, wo):
        B, Sq, D = x.shape
        H, Dh = (32, 128)
        q = (lambda x, *d: x.permute(*d))((x @ wq).reshape(B, Sq, H, Dh), 0, 2, 1, 3)
        scores = torch.einsum('bhqd,bhkd->bhqk', q, k_cache) * Dh ** (-0.5)
        p = _softmax(scores, axis=-1)
        o = torch.einsum('bhqk,bhkd->bhqd', p, v_cache)
        return (lambda x, *d: x.permute(*d))(o, 0, 2, 1, 3).reshape(B, Sq, H * Dh) @ wo

    def _B_ref(x, w1, w3, w2):
        gate = torch.einsum('bsd,df->bsf', x, w1)
        up = torch.einsum('bsd,df->bsf', x, w3)
        h = _silu(gate) * up
        out = torch.einsum('bsf,fd->bsd', h, w2)
        return out
    x = A_x
    mod = (_silu(c) @ w_mod).reshape(c.shape[0], 6, 1, -1)
    sa, ca, ga, sb, cb, gb = (mod[:, 0].clone(), mod[:, 1].clone(), mod[:, 2].clone(), mod[:, 3].clone(), mod[:, 4].clone(), mod[:, 5].clone())
    h = _layernorm(x, axis=-1) * (1 + ca) + sa
    x = x + ga * _A_ref(h, A_k_cache, A_v_cache, A_wq, A_wo)
    h = _layernorm(x, axis=-1) * (1 + cb) + sb
    x = x + gb * _B_ref(h, B_w1, B_w3, B_w2)
    return x
```

```asm
; @launch grid=(256,1,1) block=(512,1,1) lds=23552
.amdgcn_target "amdgcn-amd-amdhsa--gfx950"
.text
.p2align 10
.fill 64, 4, 0xbf800000
.globl adaLN_cond__mha_block_cached__glu_gated_swiglu__decode_kernel
.p2align 8
.type adaLN_cond__mha_block_cached__glu_gated_swiglu__decode_kernel,@function
adaLN_cond__mha_block_cached__glu_gated_swiglu__decode_kernel:
L_start:
    s_cmp_ge_u32 s2, 256
    s_cbranch_scc1 L_end
    s_load_dwordx16 s[36:51], s[0:1], 0
    s_load_dwordx8 s[52:59], s[0:1], 64
    s_load_dwordx2 s[60:61], s[0:1], 104
    v_lshrrev_b32 v1, 6, v0
    v_and_b32 v0, 63, v0
    s_and_b32 s4, s2, 7
    s_lshr_b32 s5, s2, 3
    v_readfirstlane_b32 s3, v1
    s_lshl_b32 s6, s4, 5
    s_add_u32 s6, s6, s5
    s_and_b32 s94, s5, 7
    s_lshr_b32 s95, s6, 3
    v_lshrrev_b32 v3, 4, v0
    v_and_b32 v4, 15, v0
    v_mov_b32 v8, 0
    v_mov_b32 v9, 0
    v_mov_b32 v10, 0
    v_mov_b32 v11, 0
    ds_write_b128 v8, v[8:11] offset:0
    ds_write_b128 v8, v[8:11] offset:16
    s_movk_i32 s63, 128
    s_mov_b32 s64, 3
    s_mov_b32 s65, 1
    s_mov_b32 s66, 7
    s_movk_i32 s35, 4096
    s_mov_b32 s69, 0
    s_mov_b32 s30, 0
    s_mov_b32 s98, 0
    s_mov_b32 s99, 0
    s_cmp_eq_u32 s94, 7
    s_cbranch_scc1 L_r_sp
    s_mul_i32 s96, s94, 37
    s_sub_u32 s7, s94, 5
    s_max_i32 s7, s7, 0
    s_sub_u32 s96, s96, s7
    s_min_u32 s7, s94, 1
    s_sub_u32 s96, s96, s7
    s_sub_u32 s32, s94, 1
    s_lshl_b32 s96, s96, 12
    s_lshl_b32 s7, s95, 20
    s_add_u32 s96, s96, s7
    s_and_b32 s7, s3, 3
    s_lshl_b32 s7, s7, 10
    s_add_u32 s7, s7, s96
    s_mov_b32 s68, 0x2000000
    s_cmp_ge_u32 s3, 6
    s_cbranch_scc1 L_r_v
    s_cmp_ge_u32 s3, 4
    s_cbranch_scc1 L_r_job
    s_mov_b32 s97, 3
    s_mov_b32 s62, 64
    s_movk_i32 s63, 256
    s_mov_b32 s64, 2
    s_mov_b32 s65, 3
    s_mov_b32 s66, 3
    s_mov_b32 s67, 8
    s_setprio 1
    s_branch L_common
L_r_v:
    s_mov_b32 s97, 4
    s_movk_i32 s62, 256
    s_mov_b32 s67, 16
    s_branch L_common
L_r_sp:
    s_mov_b32 s97, 5
    s_lshr_b32 s100, s5, 3
    s_lshl_b32 s101, s4, 2
    s_add_u32 s101, s101, s100
    s_lshl_b32 s7, s4, 19
    s_lshl_b32 s29, s3, 16
    s_add_u32 s7, s7, s29
    s_lshl_b32 s29, s100, 8
    s_add_u32 s7, s7, s29
    s_movk_i32 s62, 1024
    s_mov_b32 s67, 32
    s_mov_b32 s68, 0x400000
    s_cmp_eq_u32 s3, 7
    s_cbranch_scc0 L_r_sp0
    s_setprio 1
L_r_sp0:
    s_cmp_lg_u32 s3, 6
    s_cbranch_scc1 L_common
    s_getpc_b64 s[30:31]
L_pc:
    s_sub_u32 s30, s30, L_pc-L_start
    s_subb_u32 s31, s31, 0
    v_lshlrev_b32 v2, 7, v0
    v_min_u32 v5, L_end-L_start, v2
    global_load_dword v53, v5, s[30:31]
    v_add_u32 v2, 8192, v2
    v_min_u32 v5, L_end-L_start, v2
    global_load_dword v54, v5, s[30:31]
    s_mov_b32 s30, 0
    s_branch L_common
L_r_job:
    s_setprio 2
    s_cmp_eq_u32 s3, 4
    s_cselect_b32 s98, s94, 7
    s_cbranch_scc1 L_r_q
    s_cmp_eq_u32 s94, 0
    s_cbranch_scc1 L_r_q
    s_movk_i32 s62, 6144
    s_movk_i32 s35, 24576
    s_mov_b32 s67, 80
    s_mov_b32 s68, 3145728
    s_mov_b32 s69, 72
    s_cmp_ge_u32 s94, 3
    s_cbranch_scc1 L_r_rest
    s_mov_b32 s97, 1
    s_lshl_b32 s7, s95, 1
    s_add_u32 s7, s7, s94
    s_sub_u32 s7, s7, 1
    s_and_b32 s98, s7, 7
    s_lshr_b32 s99, s7, 3
    s_movk_i32 s63, 1024
    s_lshl_b32 s29, s98, 7
    s_branch L_r_mod
L_r_rest:
    s_mov_b32 s97, 2
    s_lshl_b32 s7, s95, 2
    s_add_u32 s7, s7, s94
    s_sub_u32 s7, s7, 3
    s_and_b32 s98, s7, 15
    s_lshr_b32 s99, s7, 4
    s_lshl_b32 s29, s98, 8
    s_add_u32 s29, s29, 2048
L_r_mod:
    s_mul_i32 s7, s99, 393216
    s_add_u32 s7, s7, s29
    s_lshl_b32 s30, s99, 6
    s_branch L_common
L_r_q:
    s_mov_b32 s97, 0
    s_lshl_b32 s7, s98, 19
    s_lshl_b32 s29, s95, 8
    s_add_u32 s7, s7, s29
    s_movk_i32 s62, 8192
    s_mov_b32 s35, 32768
    s_mov_b32 s67, 24
    s_mov_b32 s68, 0x400000
    s_lshl_b32 s30, s98, 6
L_common:
    v_mul_u32_u24 v2, s62, v3
    v_lshrrev_b32 v5, s64, v0
    v_and_b32 v5, s65, v5
    v_mad_u32_u24 v2, v5, s63, v2
    v_and_b32 v5, s66, v0
    v_lshl_add_u32 v2, v5, 4, v2
    v_add_u32 v2, s7, v2
    v_lshl_add_u32 v6, v4, 2, v3
    v_add_u32 v7, s30, v6
    v_lshlrev_b32 v7, 1, v7
    v_lshlrev_b32 v13, 4, v0
    s_mov_b32 s10, s68
    s_mov_b32 s11, 0x20000
    s_movk_i32 s18, 1024
    s_mov_b32 s19, 0x20000
    s_mov_b32 s29, 0
    s_waitcnt lgkmcnt(0)
    s_cmp_eq_u32 s67, 8
    s_cselect_b32 s8, s38, s8
    s_cselect_b32 s9, s39, s9
    s_cmp_eq_u32 s67, 16
    s_cselect_b32 s8, s40, s8
    s_cselect_b32 s9, s41, s9
    s_cmp_eq_u32 s67, 24
    s_cselect_b32 s8, s42, s8
    s_cselect_b32 s9, s43, s9
    s_cmp_eq_u32 s67, 32
    s_cselect_b32 s8, s44, s8
    s_cselect_b32 s9, s45, s9
    s_cmp_eq_u32 s67, 80
    s_cselect_b32 s8, s56, s8
    s_cselect_b32 s9, s57, s9
    s_cmp_eq_u32 s69, 0
    s_cselect_b32 s16, s36, s54
    s_cselect_b32 s17, s37, s55
    s_cmp_ge_u32 s97, 3
    s_cbranch_scc1 L_nosmall
    buffer_load_dwordx4 v[8:11], v13, s[16:19], 0 offen
    buffer_load_ushort v12, v7, s[16:19], 0 offen
L_nosmall:
    s_load_dword s24, s[60:61], 0
    s_cmp_lt_u32 s97, 3
    s_cselect_b64 vcc, -1, 0
    s_cmp_eq_u32 s97, 5
    s_cselect_b64 vcc, -1, vcc
    s_cmp_lt_u32 s97, 3
    s_cbranch_scc1 L_seq4
    s_barrier
    s_cmp_eq_u32 s3, 6
    s_cbranch_scc1 L_xt
L_seq4:
    buffer_load_dwordx4 v[104:107], v2, s[8:11], s29 offen nt
    s_cmp_eq_u32 s97, 4
    s_cbranch_scc1 L_vg
L_novg:
    s_add_u32 s29, s29, s35
    buffer_load_dwordx4 v[108:111], v2, s[8:11], s29 offen nt
    s_add_u32 s29, s29, s35
    buffer_load_dwordx4 v[112:115], v2, s[8:11], s29 offen nt
    s_add_u32 s29, s29, s35
    buffer_load_dwordx4 v[116:119], v2, s[8:11], s29 offen nt
    s_add_u32 s29, s29, s35
    buffer_load_dwordx4 v[120:123], v2, s[8:11], s29 offen nt
    s_add_u32 s29, s29, s35
    buffer_load_dwordx4 v[124:127], v2, s[8:11], s29 offen nt
    s_cbranch_vccnz L_nw6
    s_waitcnt vmcnt(5)
L_nw6:
    s_add_u32 s29, s29, s35
    buffer_load_dwordx4 v[128:131], v2, s[8:11], s29 offen nt
    s_cbranch_vccnz L_nw7
    s_waitcnt vmcnt(5)
L_nw7:
    s_add_u32 s29, s29, s35
    buffer_load_dwordx4 v[132:135], v2, s[8:11], s29 offen nt
    s_cbranch_vccnz L_nw8
    s_waitcnt vmcnt(5)
L_nw8:
    s_add_u32 s29, s29, s35
    buffer_load_dwordx4 v[136:139], v2, s[8:11], s29 offen nt
    s_cbranch_vccnz L_nw9
    s_waitcnt vmcnt(5)
L_nw9:
    s_add_u32 s29, s29, s35
    buffer_load_dwordx4 v[140:143], v2, s[8:11], s29 offen nt
    s_cbranch_vccnz L_nw10
    s_waitcnt vmcnt(5)
L_nw10:
    s_add_u32 s29, s29, s35
    buffer_load_dwordx4 v[144:147], v2, s[8:11], s29 offen nt
    s_cbranch_vccnz L_nw11
    s_waitcnt vmcnt(5)
L_nw11:
    s_add_u32 s29, s29, s35
    buffer_load_dwordx4 v[148:151], v2, s[8:11], s29 offen nt
    s_cbranch_vccnz L_nw12
    s_waitcnt vmcnt(5)
L_nw12:
    s_add_u32 s29, s29, s35
    buffer_load_dwordx4 v[152:155], v2, s[8:11], s29 offen nt
    s_cbranch_vccnz L_nw13
    s_waitcnt vmcnt(5)
L_nw13:
    s_add_u32 s29, s29, s35
    buffer_load_dwordx4 v[156:159], v2, s[8:11], s29 offen nt
    s_cbranch_vccnz L_nw14
    s_waitcnt vmcnt(5)
L_nw14:
    s_add_u32 s29, s29, s35
    buffer_load_dwordx4 v[160:163], v2, s[8:11], s29 offen nt
    s_cbranch_vccnz L_nw15
    s_waitcnt vmcnt(5)
L_nw15:
    s_add_u32 s29, s29, s35
    buffer_load_dwordx4 v[164:167], v2, s[8:11], s29 offen nt
    s_cmp_lt_u32 s97, 3
    s_cbranch_scc1 L_JOB
    s_cmp_eq_u32 s97, 5
    s_cbranch_scc1 L_SP
    s_waitcnt vmcnt(5)
    s_add_u32 s29, s29, s35
    buffer_load_dwordx4 v[168:171], v2, s[8:11], s29 offen nt
    s_waitcnt vmcnt(5)
    s_add_u32 s29, s29, s35
    buffer_load_dwordx4 v[172:175], v2, s[8:11], s29 offen nt
    s_waitcnt vmcnt(5)
    s_add_u32 s29, s29, s35
    buffer_load_dwordx4 v[176:179], v2, s[8:11], s29 offen nt
    s_waitcnt vmcnt(5)
    s_add_u32 s29, s29, s35
    buffer_load_dwordx4 v[180:183], v2, s[8:11], s29 offen nt
    s_waitcnt vmcnt(5)
    s_add_u32 s29, s29, s35
    buffer_load_dwordx4 v[184:187], v2, s[8:11], s29 offen nt
    s_waitcnt vmcnt(5)
    s_add_u32 s29, s29, s35
    buffer_load_dwordx4 v[188:191], v2, s[8:11], s29 offen nt
    s_waitcnt vmcnt(5)
    s_add_u32 s29, s29, s35
    buffer_load_dwordx4 v[192:195], v2, s[8:11], s29 offen nt
    s_waitcnt vmcnt(5)
    s_add_u32 s29, s29, s35
    buffer_load_dwordx4 v[196:199], v2, s[8:11], s29 offen nt
    s_waitcnt vmcnt(5)
    s_add_u32 s29, s29, s35
    buffer_load_dwordx4 v[200:203], v2, s[8:11], s29 offen nt
    s_waitcnt vmcnt(5)
    s_add_u32 s29, s29, s35
    buffer_load_dwordx4 v[204:207], v2, s[8:11], s29 offen nt
    s_waitcnt vmcnt(5)
    s_add_u32 s29, s29, s35
    buffer_load_dwordx4 v[208:211], v2, s[8:11], s29 offen nt
    s_waitcnt vmcnt(5)
    s_add_u32 s29, s29, s35
    buffer_load_dwordx4 v[212:215], v2, s[8:11], s29 offen nt
    s_add_u32 s29, s29, s35
    buffer_load_dwordx4 v[216:219], v2, s[8:11], s29 offen nt
    s_add_u32 s29, s29, s35
    buffer_load_dwordx4 v[220:223], v2, s[8:11], s29 offen nt
    s_add_u32 s29, s29, s35
    buffer_load_dwordx4 v[224:227], v2, s[8:11], s29 offen nt
    s_add_u32 s29, s29, s35
    buffer_load_dwordx4 v[228:231], v2, s[8:11], s29 offen nt
    s_add_u32 s29, s29, s35
    buffer_load_dwordx4 v[232:235], v2, s[8:11], s29 offen nt
    s_add_u32 s29, s29, s35
    buffer_load_dwordx4 v[236:239], v2, s[8:11], s29 offen nt
    s_cmp_lg_u32 s97, 3
    s_cbranch_scc1 L_nosig
    v_mov_b32 v14, 0
    v_mov_b32 v15, 1
    s_mov_b64 exec, 1
    ds_add_u32 v14, v15
    s_mov_b64 exec, -1
L_nosig:
    s_add_u32 s29, s29, s35
    buffer_load_dwordx4 v[240:243], v2, s[8:11], s29 offen nt
    s_add_u32 s29, s29, s35
    buffer_load_dwordx4 v[244:247], v2, s[8:11], s29 offen nt
    s_cmp_ge_u32 s32, 4
    s_cbranch_scc1 L_seq_end
    s_add_u32 s29, s29, s35
    buffer_load_dwordx4 v[248:251], v2, s[8:11], s29 offen nt
L_seq_end:
    s_cmp_eq_u32 s97, 4
    s_cbranch_scc1 L_v36
    v_mov_b32 v8, 0
    v_mov_b32 v6, 1
    s_mov_b32 s20, s60
    s_mov_b32 s21, s61
    s_mov_b32 s22, 0x200000
    s_mov_b32 s23, 0x20000
    v_and_b32 v5, 3, v0
    v_lshl_add_u32 v7, v3, 2, v5
    v_lshlrev_b32 v7, 4, v7
    s_mov_b32 s62, 0x000f000f
    s_mov_b32 s63, 0x000f000f
    s_lshl_b64 s[64:65], s[62:63], 4
    s_lshl_b64 s[66:67], s[62:63], 8
    s_lshl_b64 s[68:69], s[62:63], 12
    s_waitcnt lgkmcnt(0)
    s_add_u32 s24, s24, 1
    s_and_b32 s25, s24, 0xffff
    s_and_b32 s26, s24, 15
    s_mov_b32 s27, 8
    s_mov_b32 s28, 0xffff0000
    s_cmp_lg_u32 s3, 0
    s_cbranch_scc1 L_kq_wait
    v_and_b32 v9, 31, v0
    v_lshrrev_b32 v11, 5, v0
    v_lshlrev_b32 v12, 9, v11
    v_lshl_add_u32 v12, v9, 4, v12
    s_lshl_b32 s7, s95, 12
    s_add_u32 s7, s7, 131072
    v_add_u32 v12, s7, v12
    s_lshl_b32 s7, s4, 7
    s_add_u32 s7, s7, 256
    v_lshl_add_u32 v13, v9, 2, s7
    v_lshlrev_b32 v10, 2, v11
    v_lshl_add_u32 v10, v9, 3, v10
    s_getreg_b32 s30, hwreg(HW_REG_XCC_ID, 0, 4)
    s_lshl_b32 s34, s24, 8
    s_or_b32 s30, s30, s34
    s_mov_b32 s33, 0
L_poll1:
    buffer_load_dwordx4 v[72:75], v12, s[20:23], 0 offen offset:0 sc1
    buffer_load_dwordx4 v[76:79], v12, s[20:23], 0 offen offset:1024 sc1
    buffer_load_dwordx4 v[80:83], v12, s[20:23], 0 offen offset:2048 sc1
    buffer_load_dwordx4 v[84:87], v12, s[20:23], 0 offen offset:3072 sc1
    buffer_load_dword v89, v13, s[20:23], 0 offen sc1
    s_add_u32 s33, s33, 1
    s_cmp_gt_u32 s33, 200000
    s_cbranch_scc1 L_exit
    s_waitcnt vmcnt(0)
    v_xor_b32 v72, s26, v72
    v_xor_b32 v73, s26, v73
    v_xor_b32 v74, s26, v74
    v_xor_b32 v75, s26, v75
    v_xor_b32 v76, s26, v76
    v_xor_b32 v77, s26, v77
    v_xor_b32 v78, s26, v78
    v_xor_b32 v79, s26, v79
    v_xor_b32 v80, s26, v80
    v_xor_b32 v81, s26, v81
    v_xor_b32 v82, s26, v82
    v_xor_b32 v83, s26, v83
    v_xor_b32 v84, s26, v84
    v_xor_b32 v85, s26, v85
    v_xor_b32 v86, s26, v86
    v_xor_b32 v87, s26, v87
    v_or3_b32 v90, v72, v73, v74
    v_or3_b32 v91, v75, v76, v77
    v_or3_b32 v90, v90, v78, v79
    v_or3_b32 v91, v91, v80, v81
    v_or3_b32 v90, v90, v82, v83
    v_or3_b32 v91, v91, v84, v85
    v_or3_b32 v90, v90, v86, v87
    v_or_b32 v90, v90, v91
    v_and_b32 v90, 0xf, v90
    v_cmp_ne_u32 vcc, 0, v90
    s_nop 0
    s_cbranch_vccnz L_poll1
    v_cmp_ne_u32 vcc, s30, v89
    v_pk_add_f32 v[72:73], v[72:73], v[76:77]
    v_pk_add_f32 v[74:75], v[74:75], v[78:79]
    v_pk_add_f32 v[80:81], v[80:81], v[84:85]
    v_pk_add_f32 v[82:83], v[82:83], v[86:87]
    v_pk_add_f32 v[72:73], v[72:73], v[80:81]
    v_pk_add_f32 v[74:75], v[74:75], v[82:83]
    s_nop 1
    v_permlane32_swap_b32 v72, v74
    v_permlane32_swap_b32 v73, v75
    v_add_f32 v72, v72, v74
    v_add_f32 v73, v73, v75
    s_cmp_eq_u64 vcc, 0
    s_cselect_b32 s34, 1, 0
    v_cvt_pk_bf16_f32 v72, v72, v73
    v_mov_b32 v73, s34
    ds_write_b32 v10, v72 offset:64
    ds_write_b32 v8, v73 offset:4
    s_waitcnt lgkmcnt(0)
    ds_write_b32 v8, v6 offset:8
L_kq_wait:
    s_mov_b32 s33, 0
L_lpoll2:
    ds_read_b32 v9, v8 offset:8
    s_add_u32 s33, s33, 1
    s_cmp_gt_u32 s33, 800000
    s_cbranch_scc1 L_exit
    s_waitcnt lgkmcnt(0)
    v_readfirstlane_b32 s7, v9
    s_nop 0
    s_cmp_ge_u32 s7, 1
    s_cbranch_scc1 L_lgot3
    s_sleep 1
    s_branch L_lpoll2
L_lgot3:
    ds_read_b128 v[12:15], v7 offset:64
    ds_read_b32 v9, v8 offset:4
    s_waitcnt lgkmcnt(0)
    v_readfirstlane_b32 s34, v9
    v_cndmask_b32 v16, 0, v12, s[62:63]
    v_cndmask_b32 v17, 0, v13, s[62:63]
    v_cndmask_b32 v18, 0, v14, s[62:63]
    v_cndmask_b32 v19, 0, v15, s[62:63]
    v_cndmask_b32 v20, 0, v12, s[64:65]
    v_cndmask_b32 v21, 0, v13, s[64:65]
    v_cndmask_b32 v22, 0, v14, s[64:65]
    v_cndmask_b32 v23, 0, v15, s[64:65]
    v_cndmask_b32 v24, 0, v12, s[66:67]
    v_cndmask_b32 v25, 0, v13, s[66:67]
    v_cndmask_b32 v26, 0, v14, s[66:67]
    v_cndmask_b32 v27, 0, v15, s[66:67]
    v_cndmask_b32 v28, 0, v12, s[68:69]
    v_cndmask_b32 v29, 0, v13, s[68:69]
    v_cndmask_b32 v30, 0, v14, s[68:69]
    v_cndmask_b32 v31, 0, v15, s[68:69]
    s_waitcnt vmcnt(0)
    v_mfma_f32_16x16x32_bf16 v[32:35], v[104:107], v[16:19], 0
    v_mfma_f32_16x16x32_bf16 v[32:35], v[108:111], v[20:23], v[32:35]
    v_mfma_f32_16x16x32_bf16 v[32:35], v[112:115], v[24:27], v[32:35]
    v_mfma_f32_16x16x32_bf16 v[32:35], v[116:119], v[28:31], v[32:35]
    v_mfma_f32_16x16x32_bf16 v[36:39], v[120:123], v[16:19], 0
    v_mfma_f32_16x16x32_bf16 v[36:39], v[124:127], v[20:23], v[36:39]
    v_mfma_f32_16x16x32_bf16 v[36:39], v[128:131], v[24:27], v[36:39]
    v_mfma_f32_16x16x32_bf16 v[36:39], v[132:135], v[28:31], v[36:39]
    v_mfma_f32_16x16x32_bf16 v[40:43], v[136:139], v[16:19], 0
    v_mfma_f32_16x16x32_bf16 v[40:43], v[140:143], v[20:23], v[40:43]
    v_mfma_f32_16x16x32_bf16 v[40:43], v[144:147], v[24:27], v[40:43]
    v_mfma_f32_16x16x32_bf16 v[40:43], v[148:151], v[28:31], v[40:43]
    v_mfma_f32_16x16x32_bf16 v[44:47], v[152:155], v[16:19], 0
    v_mfma_f32_16x16x32_bf16 v[44:47], v[156:159], v[20:23], v[44:47]
    v_mfma_f32_16x16x32_bf16 v[44:47], v[160:163], v[24:27], v[44:47]
    v_mfma_f32_16x16x32_bf16 v[44:47], v[164:167], v[28:31], v[44:47]
    v_mfma_f32_16x16x32_bf16 v[48:51], v[168:171], v[16:19], 0
    v_mfma_f32_16x16x32_bf16 v[48:51], v[172:175], v[20:23], v[48:51]
    v_mfma_f32_16x16x32_bf16 v[48:51], v[176:179], v[24:27], v[48:51]
    v_mfma_f32_16x16x32_bf16 v[48:51], v[180:183], v[28:31], v[48:51]
    v_mfma_f32_16x16x32_bf16 v[52:55], v[184:187], v[16:19], 0
    v_mfma_f32_16x16x32_bf16 v[52:55], v[188:191], v[20:23], v[52:55]
    v_mfma_f32_16x16x32_bf16 v[52:55], v[192:195], v[24:27], v[52:55]
    v_mfma_f32_16x16x32_bf16 v[52:55], v[196:199], v[28:31], v[52:55]
    v_mfma_f32_16x16x32_bf16 v[56:59], v[200:203], v[16:19], 0
    v_mfma_f32_16x16x32_bf16 v[56:59], v[204:207], v[20:23], v[56:59]
    v_mfma_f32_16x16x32_bf16 v[56:59], v[208:211], v[24:27], v[56:59]
    v_mfma_f32_16x16x32_bf16 v[56:59], v[212:215], v[28:31], v[56:59]
    v_mfma_f32_16x16x32_bf16 v[60:63], v[216:219], v[16:19], 0
    v_mfma_f32_16x16x32_bf16 v[60:63], v[220:223], v[20:23], v[60:63]
    v_mfma_f32_16x16x32_bf16 v[60:63], v[224:227], v[24:27], v[60:63]
    v_mfma_f32_16x16x32_bf16 v[60:63], v[228:231], v[28:31], v[60:63]
    v_mfma_f32_16x16x32_bf16 v[64:67], v[232:235], v[16:19], 0
    v_mfma_f32_16x16x32_bf16 v[64:67], v[236:239], v[20:23], v[64:67]
    v_mfma_f32_16x16x32_bf16 v[64:67], v[240:243], v[24:27], v[64:67]
    v_mfma_f32_16x16x32_bf16 v[64:67], v[244:247], v[28:31], v[64:67]
    s_cmp_ge_u32 s32, 4
    s_cselect_b64 s[62:63], 0, s[62:63]
    v_mfma_f32_16x16x32_bf16 v[68:71], v[248:251], v[16:19], 0
    v_mov_b32_dpp v72, v32 quad_perm:[0,0,0,0] row_mask:0xf bank_mask:0xf
    v_mov_b32_dpp v73, v36 quad_perm:[0,0,0,0] row_mask:0xf bank_mask:0xf
    v_mov_b32_dpp v74, v40 quad_perm:[0,0,0,0] row_mask:0xf bank_mask:0xf
    v_mov_b32_dpp v75, v44 quad_perm:[0,0,0,0] row_mask:0xf bank_mask:0xf
    v_mov_b32_dpp v76, v48 quad_perm:[0,0,0,0] row_mask:0xf bank_mask:0xf
    v_mov_b32_dpp v77, v52 quad_perm:[0,0,0,0] row_mask:0xf bank_mask:0xf
    v_mov_b32_dpp v78, v56 quad_perm:[0,0,0,0] row_mask:0xf bank_mask:0xf
    v_mov_b32_dpp v79, v60 quad_perm:[0,0,0,0] row_mask:0xf bank_mask:0xf
    v_mov_b32_dpp v80, v64 quad_perm:[0,0,0,0] row_mask:0xf bank_mask:0xf
    v_mov_b32_dpp v81, v68 quad_perm:[0,0,0,0] row_mask:0xf bank_mask:0xf
    v_add_f32_dpp v72, v33, v72 quad_perm:[1,1,1,1] row_mask:0xf bank_mask:0xf
    v_add_f32_dpp v73, v37, v73 quad_perm:[1,1,1,1] row_mask:0xf bank_mask:0xf
    v_add_f32_dpp v74, v41, v74 quad_perm:[1,1,1,1] row_mask:0xf bank_mask:0xf
    v_add_f32_dpp v75, v45, v75 quad_perm:[1,1,1,1] row_mask:0xf bank_mask:0xf
    v_add_f32_dpp v76, v49, v76 quad_perm:[1,1,1,1] row_mask:0xf bank_mask:0xf
    v_add_f32_dpp v77, v53, v77 quad_perm:[1,1,1,1] row_mask:0xf bank_mask:0xf
    v_add_f32_dpp v78, v57, v78 quad_perm:[1,1,1,1] row_mask:0xf bank_mask:0xf
    v_add_f32_dpp v79, v61, v79 quad_perm:[1,1,1,1] row_mask:0xf bank_mask:0xf
    v_add_f32_dpp v80, v65, v80 quad_perm:[1,1,1,1] row_mask:0xf bank_mask:0xf
    v_add_f32_dpp v81, v69, v81 quad_perm:[1,1,1,1] row_mask:0xf bank_mask:0xf
    v_add_f32_dpp v72, v34, v72 quad_perm:[2,2,2,2] row_mask:0xf bank_mask:0xf
    v_add_f32_dpp v73, v38, v73 quad_perm:[2,2,2,2] row_mask:0xf bank_mask:0xf
    v_add_f32_dpp v74, v42, v74 quad_perm:[2,2,2,2] row_mask:0xf bank_mask:0xf
    v_add_f32_dpp v75, v46, v75 quad_perm:[2,2,2,2] row_mask:0xf bank_mask:0xf
    v_add_f32_dpp v76, v50, v76 quad_perm:[2,2,2,2] row_mask:0xf bank_mask:0xf
    v_add_f32_dpp v77, v54, v77 quad_perm:[2,2,2,2] row_mask:0xf bank_mask:0xf
    v_add_f32_dpp v78, v58, v78 quad_perm:[2,2,2,2] row_mask:0xf bank_mask:0xf
    v_add_f32_dpp v79, v62, v79 quad_perm:[2,2,2,2] row_mask:0xf bank_mask:0xf
    v_add_f32_dpp v80, v66, v80 quad_perm:[2,2,2,2] row_mask:0xf bank_mask:0xf
    v_add_f32_dpp v81, v70, v81 quad_perm:[2,2,2,2] row_mask:0xf bank_mask:0xf
    v_add_f32_dpp v72, v35, v72 quad_perm:[3,3,3,3] row_mask:0xf bank_mask:0xf
    v_add_f32_dpp v73, v39, v73 quad_perm:[3,3,3,3] row_mask:0xf bank_mask:0xf
    v_add_f32_dpp v74, v43, v74 quad_perm:[3,3,3,3] row_mask:0xf bank_mask:0xf
    v_add_f32_dpp v75, v47, v75 quad_perm:[3,3,3,3] row_mask:0xf bank_mask:0xf
    v_add_f32_dpp v76, v51, v76 quad_perm:[3,3,3,3] row_mask:0xf bank_mask:0xf
    v_add_f32_dpp v77, v55, v77 quad_perm:[3,3,3,3] row_mask:0xf bank_mask:0xf
    v_add_f32_dpp v78, v59, v78 quad_perm:[3,3,3,3] row_mask:0xf bank_mask:0xf
    v_add_f32_dpp v79, v63, v79 quad_perm:[3,3,3,3] row_mask:0xf bank_mask:0xf
    v_add_f32_dpp v80, v67, v80 quad_perm:[3,3,3,3] row_mask:0xf bank_mask:0xf
    v_add_f32_dpp v81, v71, v81 quad_perm:[3,3,3,3] row_mask:0xf bank_mask:0xf
    s_mov_b32 s7, 0x3db504f3
    v_cvt_pk_bf16_f32 v84, v72, v73
    v_lshlrev_b32 v72, 16, v84
    v_and_b32 v73, s28, v84
    v_cvt_pk_bf16_f32 v85, v74, v75
    v_lshlrev_b32 v74, 16, v85
    v_and_b32 v75, s28, v85
    v_cvt_pk_bf16_f32 v86, v76, v77
    v_lshlrev_b32 v76, 16, v86
    v_and_b32 v77, s28, v86
    v_cvt_pk_bf16_f32 v87, v78, v79
    v_lshlrev_b32 v78, 16, v87
    v_and_b32 v79, s28, v87
    v_cvt_pk_bf16_f32 v88, v80, v81
    v_lshlrev_b32 v80, 16, v88
    v_and_b32 v81, s28, v88
    v_mul_f32 v72, s7, v72
    v_mul_f32 v73, s7, v73
    v_mul_f32 v74, s7, v74
    v_mul_f32 v75, s7, v75
    v_mul_f32 v76, s7, v76
    v_mul_f32 v77, s7, v77
    v_mul_f32 v78, s7, v78
    v_mul_f32 v79, s7, v79
    v_mul_f32 v80, s7, v80
    v_mul_f32 v81, s7, v81
    v_cvt_pk_bf16_f32 v84, v72, v73
    v_lshlrev_b32 v72, 16, v84
    v_and_b32 v73, s28, v84
    v_cvt_pk_bf16_f32 v85, v74, v75
    v_lshlrev_b32 v74, 16, v85
    v_and_b32 v75, s28, v85
    v_cvt_pk_bf16_f32 v86, v76, v77
    v_lshlrev_b32 v76, 16, v86
    v_and_b32 v77, s28, v86
    v_cvt_pk_bf16_f32 v87, v78, v79
    v_lshlrev_b32 v78, 16, v87
    v_and_b32 v79, s28, v87
    v_cvt_pk_bf16_f32 v88, v80, v81
    v_lshlrev_b32 v80, 16, v88
    v_and_b32 v81, s28, v88
    v_mov_b32 v84, 0xff800000
    v_cndmask_b32 v81, v84, v81, s[62:63]
    v_max3_f32 v84, v72, v73, v74
    v_max3_f32 v85, v75, v76, v77
    v_max3_f32 v86, v78, v79, v80
    v_max3_f32 v84, v84, v85, v86
    v_max_f32 v84, v84, v81
    s_nop 1
    v_max_f32_dpp v84, v84, v84 row_ror:4 row_mask:0xf bank_mask:0xf
    s_nop 1
    v_max_f32_dpp v84, v84, v84 row_ror:8 row_mask:0xf bank_mask:0xf
    v_mov_b32 v85, v84
    s_nop 1
    v_permlane16_swap_b32 v84, v85
    v_max_f32 v84, v84, v85
    v_mov_b32 v85, v84
    s_nop 1
    v_permlane32_swap_b32 v84, v85
    v_max_f32 v84, v84, v85
    s_lshl_b32 s29, s3, 2
    v_mov_b32 v85, s29
    ds_write_b32 v85, v84 offset:32
    s_waitcnt lgkmcnt(0)
    s_mov_b64 exec, 1
    ds_add_u32 v8, v6 offset:12
    s_mov_b64 exec, -1
    s_mov_b32 s33, 0
L_lpoll4:
    ds_read_b32 v9, v8 offset:12
    s_add_u32 s33, s33, 1
    s_cmp_gt_u32 s33, 800000
    s_cbranch_scc1 L_exit
    s_waitcnt lgkmcnt(0)
    v_readfirstlane_b32 s7, v9
    s_nop 0
    s_cmp_ge_u32 s7, 4
    s_cbranch_scc1 L_lgot5
    s_sleep 1
    s_branch L_lpoll4
L_lgot5:
    ds_read_b128 v[88:91], v8 offset:32
    s_mov_b32 s7, 0x3fb8aa3b
    s_waitcnt lgkmcnt(0)
    v_max3_f32 v84, v88, v89, v90
    v_max_f32 v84, v84, v91
    v_sub_f32 v72, v72, v84
    v_sub_f32 v73, v73, v84
    v_sub_f32 v74, v74, v84
    v_sub_f32 v75, v75, v84
    v_sub_f32 v76, v76, v84
    v_sub_f32 v77, v77, v84
    v_sub_f32 v78, v78, v84
    v_sub_f32 v79, v79, v84
    v_sub_f32 v80, v80, v84
    v_sub_f32 v81, v81, v84
    v_mul_f32 v72, s7, v72
    v_mul_f32 v73, s7, v73
    v_mul_f32 v74, s7, v74
    v_mul_f32 v75, s7, v75
    v_mul_f32 v76, s7, v76
    v_mul_f32 v77, s7, v77
    v_mul_f32 v78, s7, v78
    v_mul_f32 v79, s7, v79
    v_mul_f32 v80, s7, v80
    v_mul_f32 v81, s7, v81
    v_exp_f32 v72, v72
    v_exp_f32 v73, v73
    v_exp_f32 v74, v74
    v_exp_f32 v75, v75
    v_exp_f32 v76, v76
    v_exp_f32 v77, v77
    v_exp_f32 v78, v78
    v_exp_f32 v79, v79
    v_exp_f32 v80, v80
    v_exp_f32 v81, v81
    v_cvt_pk_bf16_f32 v72, v72, v72
    v_cvt_pk_bf16_f32 v73, v73, v73
    v_cvt_pk_bf16_f32 v74, v74, v74
    v_cvt_pk_bf16_f32 v75, v75, v75
    v_cvt_pk_bf16_f32 v76, v76, v76
    v_cvt_pk_bf16_f32 v77, v77, v77
    v_cvt_pk_bf16_f32 v78, v78, v78
    v_cvt_pk_bf16_f32 v79, v79, v79
    v_cvt_pk_bf16_f32 v80, v80, v80
    v_cvt_pk_bf16_f32 v81, v81, v81
    s_mul_i32 s29, s3, 3072
    s_add_u32 s29, s29, 1024
    v_lshl_add_u32 v94, v0, 4, s29
    ds_write_b128 v94, v[72:75]
    ds_write_b128 v94, v[76:79] offset:1024
    ds_write_b128 v94, v[80:83] offset:2048
    v_and_b32 v32, s28, v72
    v_and_b32 v33, s28, v73
    v_and_b32 v34, s28, v74
    v_and_b32 v35, s28, v75
    v_and_b32 v36, s28, v76
    v_and_b32 v37, s28, v77
    v_and_b32 v38, s28, v78
    v_and_b32 v39, s28, v79
    v_and_b32 v40, s28, v80
    v_and_b32 v41, s28, v81
    v_add_f32 v86, v32, v33
    v_add_f32 v87, v34, v35
    v_add_f32 v88, v36, v37
    v_add_f32 v89, v38, v39
    v_add_f32 v90, v40, v41
    v_add_f32 v86, v86, v87
    v_add_f32 v88, v88, v89
    v_add_f32 v86, v86, v90
    v_add_f32 v86, v86, v88
    s_nop 1
    v_add_f32_dpp v86, v86, v86 row_ror:4 row_mask:0xf bank_mask:0xf
    s_nop 1
    v_add_f32_dpp v86, v86, v86 row_ror:8 row_mask:0xf bank_mask:0xf
    v_mov_b32 v87, v86
    s_nop 1
    v_permlane16_swap_b32 v86, v87
    v_add_f32 v86, v86, v87
    v_mov_b32 v87, v86
    s_nop 1
    v_permlane32_swap_b32 v86, v87
    v_add_f32 v86, v86, v87
    ds_write_b32 v85, v86 offset:48
    s_waitcnt lgkmcnt(0)
    s_mov_b64 exec, 1
    ds_add_u32 v8, v6 offset:16
    s_mov_b64 exec, -1
    s_cmp_lg_u32 s3, 0
    s_cbranch_scc1 L_k_b2
    s_mov_b32 s33, 0
L_lpoll6:
    ds_read_b32 v9, v8 offset:16
    s_add_u32 s33, s33, 1
    s_cmp_gt_u32 s33, 800000
    s_cbranch_scc1 L_exit
    s_waitcnt lgkmcnt(0)
    v_readfirstlane_b32 s7, v9
    s_nop 0
    s_cmp_ge_u32 s7, 4
    s_cbranch_scc1 L_lgot7
    s_sleep 1
    s_branch L_lpoll6
L_lgot7:
    ds_read_b128 v[88:91], v8 offset:48
    s_lshl_b32 s29, s6, 7
    s_add_u32 s29, s29, 655360
    v_mov_b32 v92, s29
    s_waitcnt lgkmcnt(0)
    v_add_f32 v88, v88, v89
    v_add_f32 v90, v90, v91
    v_add_f32 v89, v88, v90
    v_or_b32 v88, s25, v84
    v_mov_b32 v90, s24
    v_mov_b32 v91, s24
    s_mov_b64 exec, 1
    s_cmp_eq_u32 s34, 1
    s_cbranch_scc1 L_ml_fast
    buffer_store_dwordx4 v[88:91], v92, s[20:23], 0 offen sc1
    s_branch L_ml_done
L_ml_fast:
    buffer_store_dwordx4 v[88:91], v92, s[20:23], 0 offen
L_ml_done:
    s_mov_b64 exec, -1
L_k_b2:
    s_lshr_b32 s7, s5, 3
    s_mul_i32 s7, s7, 7
    s_add_u32 s7, s7, s94
    s_lshl_b32 s7, s7, 2
    s_add_u32 s7, s7, s3
    s_mul_i32 s7, s7, 14
    s_mul_i32 s29, s4, 1536
    s_add_u32 s7, s7, s29
    v_min_u32 v18, 13, v0
    v_add_u32 v18, s7, v18
    v_lshlrev_b32 v18, 7, v18
    s_mov_b32 s16, s52
    s_mov_b32 s17, s53
    s_mov_b32 s18, 0x158000
    s_mov_b32 s19, 0x20000
    s_barrier
    s_mov_b64 exec, 0x3fff
    buffer_load_dword v20, v18, s[16:19], 0 offen
    s_branch L_exit
L_xt:
    s_setprio 3
    s_mov_b32 s20, s60
    s_mov_b32 s21, s61
    s_mov_b32 s22, 2097152
    s_mov_b32 s23, 0x20000
    s_getreg_b32 s30, hwreg(HW_REG_XCC_ID, 0, 4)
    s_lshl_b32 s7, s6, 2
    s_add_u32 s7, s7, 256
    v_mov_b32 v14, s7
    s_waitcnt lgkmcnt(0)
    s_add_u32 s7, s24, 1
    s_lshl_b32 s7, s7, 8
    s_or_b32 s30, s30, s7
    v_mov_b32 v15, s30
    s_mov_b64 exec, 1
    buffer_store_dword v15, v14, s[20:23], 0 offen sc1
    s_mov_b64 exec, -1
    s_setprio 0
    s_branch L_seq4
L_vg:
    v_mov_b32 v14, 0
    s_mov_b32 s33, 0
L_lpoll8:
    ds_read_b32 v15, v14 offset:0
    s_add_u32 s33, s33, 1
    s_cmp_gt_u32 s33, 800000
    s_cbranch_scc1 L_exit
    s_waitcnt lgkmcnt(0)
    v_readfirstlane_b32 s7, v15
    s_nop 0
    s_cmp_ge_u32 s7, 4
    s_cbranch_scc1 L_lgot9
    s_sleep 1
    s_branch L_lpoll8
L_lgot9:
    s_branch L_novg
L_JOB:
    s_barrier
    s_mov_b32 s20, s60
    s_mov_b32 s21, s61
    s_mov_b32 s22, 0x200000
    s_mov_b32 s23, 0x20000
    v_and_b32 v13, 15, v0
    v_and_b32 v14, 1, v0
    v_mov_b32 v15, 0xffff
    v_lshlrev_b32 v14, 4, v14
    v_lshlrev_b32 v15, v14, v15
    v_lshrrev_b32 v13, 1, v13
    v_cmp_eq_u32 vcc, 0, v13
    s_nop 1
    v_cndmask_b32 v24, 0, v15, vcc
    v_cmp_eq_u32 vcc, 1, v13
    s_nop 1
    v_cndmask_b32 v25, 0, v15, vcc
    v_cmp_eq_u32 vcc, 2, v13
    s_nop 1
    v_cndmask_b32 v26, 0, v15, vcc
    v_cmp_eq_u32 vcc, 3, v13
    s_nop 1
    v_cndmask_b32 v27, 0, v15, vcc
    s_waitcnt lgkmcnt(0)
    s_add_u32 s24, s24, 1
    s_and_b32 s25, s24, 0xffff
    s_and_b32 s26, s24, 15
    s_mov_b32 s27, 8
    s_mov_b32 s28, 0xffff0000
    s_lshl_b32 s7, s95, 3
    s_add_u32 s7, s7, s98
    s_lshl_b32 s7, s7, 9
    s_add_u32 s7, s7, 131072
    s_lshl_b32 s29, s98, 3
    s_add_u32 s29, s29, s99
    s_lshl_b32 s29, s29, 9
    s_add_u32 s35, s29, 4096
    s_add_u32 s29, s29, 65536
    s_cmp_eq_u32 s97, 1
    s_cselect_b32 s7, s35, s7
    s_cmp_eq_u32 s97, 2
    s_cselect_b32 s7, s29, s7
    v_lshlrev_b32 v31, 5, v4
    v_lshl_add_u32 v31, v3, 4, v31
    v_add_u32 v31, s7, v31
    s_waitcnt vmcnt(16)
    v_lshlrev_b32 v12, 16, v12
    s_cmp_eq_u32 s97, 0
    s_cbranch_scc1 L_job_q
    s_mov_b32 s7, 0xbfb8aa3b
    v_mul_f32 v17, s7, v12
    v_exp_f32 v17, v17
    s_nop 0
    v_add_f32 v17, 1.0, v17
    v_rcp_f32 v17, v17
    s_nop 0
    v_mul_f32 v16, v12, v17
    v_cvt_pk_bf16_f32 v16, v16, v16
    s_mov_b32 s34, 0
    s_branch L_job_mm
L_job_q:
    v_lshlrev_b32 v16, 16, v8
    v_and_b32 v17, s28, v8
    v_lshlrev_b32 v18, 16, v9
    v_and_b32 v19, s28, v9
    v_lshlrev_b32 v20, 16, v10
    v_and_b32 v21, s28, v10
    v_lshlrev_b32 v22, 16, v11
    v_and_b32 v23, s28, v11
    v_add_f32 v32, v16, v17
    v_add_f32 v33, v18, v19
    v_add_f32 v34, v20, v21
    v_add_f32 v35, v22, v23
    v_add_f32 v32, v32, v33
    v_add_f32 v34, v34, v35
    v_add_f32 v32, v32, v34
    s_nop 1
    v_add_f32_dpp v32, v32, v32 quad_perm:[1,0,3,2] row_mask:0xf bank_mask:0xf
    s_nop 1
    v_add_f32_dpp v32, v32, v32 quad_perm:[2,3,0,1] row_mask:0xf bank_mask:0xf
    s_nop 1
    v_add_f32_dpp v32, v32, v32 row_half_mirror row_mask:0xf bank_mask:0xf
    s_nop 1
    v_add_f32_dpp v32, v32, v32 row_mirror row_mask:0xf bank_mask:0xf
    v_mov_b32 v33, v32
    s_nop 1
    v_permlane16_swap_b32 v32, v33
    v_add_f32 v32, v32, v33
    v_mov_b32 v33, v32
    s_nop 1
    v_permlane32_swap_b32 v32, v33
    v_add_f32 v32, v32, v33
    s_mov_b32 s29, 0x3b000000
    v_mul_f32 v32, s29, v32
    v_sub_f32 v16, v16, v32
    v_sub_f32 v17, v17, v32
    v_sub_f32 v18, v18, v32
    v_sub_f32 v19, v19, v32
    v_sub_f32 v20, v20, v32
    v_sub_f32 v21, v21, v32
    v_sub_f32 v22, v22, v32
    v_sub_f32 v23, v23, v32
    v_mul_f32 v33, v16, v16
    v_fmac_f32 v33, v17, v17
    v_fmac_f32 v33, v18, v18
    v_fmac_f32 v33, v19, v19
    v_fmac_f32 v33, v20, v20
    v_fmac_f32 v33, v21, v21
    v_fmac_f32 v33, v22, v22
    v_fmac_f32 v33, v23, v23
    s_nop 1
    v_add_f32_dpp v33, v33, v33 quad_perm:[1,0,3,2] row_mask:0xf bank_mask:0xf
    s_nop 1
    v_add_f32_dpp v33, v33, v33 quad_perm:[2,3,0,1] row_mask:0xf bank_mask:0xf
    s_nop 1
    v_add_f32_dpp v33, v33, v33 row_half_mirror row_mask:0xf bank_mask:0xf
    s_nop 1
    v_add_f32_dpp v33, v33, v33 row_mirror row_mask:0xf bank_mask:0xf
    v_mov_b32 v34, v33
    s_nop 1
    v_permlane16_swap_b32 v33, v34
    v_add_f32 v33, v33, v34
    v_mov_b32 v34, v33
    s_nop 1
    v_permlane32_swap_b32 v33, v34
    v_add_f32 v33, v33, v34
    v_mul_f32 v33, s29, v33
    v_cvt_pk_bf16_f32 v34, v32, v33
    v_lshlrev_b32 v32, 16, v34
    v_and_b32 v33, s28, v34
    s_mov_b32 s7, 0x3727c5ac
    v_add_f32 v33, s7, v33
    v_cvt_pk_bf16_f32 v33, v33, v33
    v_lshlrev_b32 v33, 16, v33
    v_sqrt_f32 v33, v33
    v_sub_f32 v12, v12, v32
    v_cvt_pk_bf16_f32 v33, v33, v33
    v_lshlrev_b32 v33, 16, v33
    v_cvt_pk_bf16_f32 v12, v12, v12
    v_lshlrev_b32 v12, 16, v12
    v_rcp_f32 v33, v33
    s_nop 0
    v_mul_f32 v12, v12, v33
    v_cvt_pk_bf16_f32 v12, v12, v12
    v_lshlrev_b32 v12, 16, v12
    v_and_b32 v9, 31, v0
    v_lshrrev_b32 v11, 5, v0
    v_lshlrev_b32 v10, 9, v11
    v_lshl_add_u32 v10, v9, 4, v10
    s_lshl_b32 s7, s98, 12
    s_add_u32 s7, s7, 4096
    v_add_u32 v10, s7, v10
    s_lshl_b32 s7, s4, 7
    s_add_u32 s7, s7, 256
    v_lshl_add_u32 v13, v9, 2, s7
    s_getreg_b32 s30, hwreg(HW_REG_XCC_ID, 0, 4)
    s_lshl_b32 s34, s24, 8
    s_or_b32 s30, s30, s34
    s_waitcnt vmcnt(0)
    s_sleep 64
    s_mov_b32 s33, 0
L_poll10:
    buffer_load_dwordx4 v[40:43], v10, s[20:23], 0 offen offset:0 sc1
    buffer_load_dwordx4 v[44:47], v10, s[20:23], 0 offen offset:1024 sc1
    buffer_load_dwordx4 v[48:51], v10, s[20:23], 0 offen offset:2048 sc1
    buffer_load_dwordx4 v[52:55], v10, s[20:23], 0 offen offset:3072 sc1
    buffer_load_dword v57, v13, s[20:23], 0 offen sc1
    s_add_u32 s33, s33, 1
    s_cmp_gt_u32 s33, 200000
    s_cbranch_scc1 L_exit
    s_waitcnt vmcnt(0)
    v_xor_b32 v40, s26, v40
    v_xor_b32 v41, s26, v41
    v_xor_b32 v42, s26, v42
    v_xor_b32 v43, s26, v43
    v_xor_b32 v44, s26, v44
    v_xor_b32 v45, s26, v45
    v_xor_b32 v46, s26, v46
    v_xor_b32 v47, s26, v47
    v_xor_b32 v48, s26, v48
    v_xor_b32 v49, s26, v49
    v_xor_b32 v50, s26, v50
    v_xor_b32 v51, s26, v51
    v_xor_b32 v52, s26, v52
    v_xor_b32 v53, s26, v53
    v_xor_b32 v54, s26, v54
    v_xor_b32 v55, s26, v55
    v_or3_b32 v58, v40, v41, v42
    v_or3_b32 v59, v43, v44, v45
    v_or3_b32 v58, v58, v46, v47
    v_or3_b32 v59, v59, v48, v49
    v_or3_b32 v58, v58, v50, v51
    v_or3_b32 v59, v59, v52, v53
    v_or3_b32 v58, v58, v54, v55
    v_or_b32 v58, v58, v59
    v_and_b32 v58, 0xf, v58
    v_cmp_ne_u32 vcc, 0, v58
    s_nop 0
    s_cbranch_vccnz L_poll10
    v_cmp_ne_u32 vcc, s30, v57
    s_nop 0
    s_cmp_eq_u64 vcc, 0
    s_cselect_b32 s34, 1, 0
    v_pk_add_f32 v[40:41], v[40:41], v[44:45]
    v_pk_add_f32 v[42:43], v[42:43], v[46:47]
    v_pk_add_f32 v[48:49], v[48:49], v[52:53]
    v_pk_add_f32 v[50:51], v[50:51], v[54:55]
    v_pk_add_f32 v[40:41], v[40:41], v[48:49]
    v_pk_add_f32 v[42:43], v[42:43], v[50:51]
    s_nop 1
    v_permlane32_swap_b32 v40, v42
    v_permlane32_swap_b32 v41, v43
    v_add_f32 v40, v40, v42
    v_add_f32 v41, v41, v43
    s_nop 1
    v_permlane16_swap_b32 v40, v41
    v_cvt_pk_bf16_f32 v42, v40, v41
    v_lshlrev_b32 v40, 16, v42
    v_and_b32 v41, s28, v42
    v_add_f32 v41, 1.0, v41
    v_cvt_pk_bf16_f32 v41, v41, v41
    v_lshlrev_b32 v41, 16, v41
    v_mul_f32 v41, v12, v41
    v_cvt_pk_bf16_f32 v41, v41, v41
    v_lshlrev_b32 v41, 16, v41
    v_add_f32 v41, v41, v40
    v_cvt_pk_bf16_f32 v16, v41, v41
L_job_mm:
    s_nop 1
    v_and_b32_dpp v32, v16, v24 row_newbcast:0 row_mask:0xf bank_mask:0xf
    v_and_b32_dpp v33, v16, v25 row_newbcast:0 row_mask:0xf bank_mask:0xf
    v_and_b32_dpp v34, v16, v26 row_newbcast:0 row_mask:0xf bank_mask:0xf
    v_and_b32_dpp v35, v16, v27 row_newbcast:0 row_mask:0xf bank_mask:0xf
    v_and_b32_dpp v36, v16, v24 row_newbcast:1 row_mask:0xf bank_mask:0xf
    v_and_b32_dpp v37, v16, v25 row_newbcast:1 row_mask:0xf bank_mask:0xf
    v_and_b32_dpp v38, v16, v26 row_newbcast:1 row_mask:0xf bank_mask:0xf
    v_and_b32_dpp v39, v16, v27 row_newbcast:1 row_mask:0xf bank_mask:0xf
    s_waitcnt vmcnt(15)
    v_mfma_f32_16x16x32_bf16 v[40:43], v[32:35], v[104:107], 0
    v_and_b32_dpp v32, v16, v24 row_newbcast:2 row_mask:0xf bank_mask:0xf
    v_and_b32_dpp v33, v16, v25 row_newbcast:2 row_mask:0xf bank_mask:0xf
    v_and_b32_dpp v34, v16, v26 row_newbcast:2 row_mask:0xf bank_mask:0xf
    v_and_b32_dpp v35, v16, v27 row_newbcast:2 row_mask:0xf bank_mask:0xf
    s_waitcnt vmcnt(14)
    v_mfma_f32_16x16x32_bf16 v[40:43], v[36:39], v[108:111], v[40:43]
    v_and_b32_dpp v36, v16, v24 row_newbcast:3 row_mask:0xf bank_mask:0xf
    v_and_b32_dpp v37, v16, v25 row_newbcast:3 row_mask:0xf bank_mask:0xf
    v_and_b32_dpp v38, v16, v26 row_newbcast:3 row_mask:0xf bank_mask:0xf
    v_and_b32_dpp v39, v16, v27 row_newbcast:3 row_mask:0xf bank_mask:0xf
    s_waitcnt vmcnt(13)
    v_mfma_f32_16x16x32_bf16 v[40:43], v[32:35], v[112:115], v[40:43]
    v_and_b32_dpp v32, v16, v24 row_newbcast:4 row_mask:0xf bank_mask:0xf
    v_and_b32_dpp v33, v16, v25 row_newbcast:4 row_mask:0xf bank_mask:0xf
    v_and_b32_dpp v34, v16, v26 row_newbcast:4 row_mask:0xf bank_mask:0xf
    v_and_b32_dpp v35, v16, v27 row_newbcast:4 row_mask:0xf bank_mask:0xf
    s_waitcnt vmcnt(12)
    v_mfma_f32_16x16x32_bf16 v[40:43], v[36:39], v[116:119], v[40:43]
    v_and_b32_dpp v36, v16, v24 row_newbcast:5 row_mask:0xf bank_mask:0xf
    v_and_b32_dpp v37, v16, v25 row_newbcast:5 row_mask:0xf bank_mask:0xf
    v_and_b32_dpp v38, v16, v26 row_newbcast:5 row_mask:0xf bank_mask:0xf
    v_and_b32_dpp v39, v16, v27 row_newbcast:5 row_mask:0xf bank_mask:0xf
    s_waitcnt vmcnt(11)
    v_mfma_f32_16x16x32_bf16 v[40:43], v[32:35], v[120:123], v[40:43]
    v_and_b32_dpp v32, v16, v24 row_newbcast:6 row_mask:0xf bank_mask:0xf
    v_and_b32_dpp v33, v16, v25 row_newbcast:6 row_mask:0xf bank_mask:0xf
    v_and_b32_dpp v34, v16, v26 row_newbcast:6 row_mask:0xf bank_mask:0xf
    v_and_b32_dpp v35, v16, v27 row_newbcast:6 row_mask:0xf bank_mask:0xf
    s_waitcnt vmcnt(10)
    v_mfma_f32_16x16x32_bf16 v[40:43], v[36:39], v[124:127], v[40:43]
    v_and_b32_dpp v36, v16, v24 row_newbcast:7 row_mask:0xf bank_mask:0xf
    v_and_b32_dpp v37, v16, v25 row_newbcast:7 row_mask:0xf bank_mask:0xf
    v_and_b32_dpp v38, v16, v26 row_newbcast:7 row_mask:0xf bank_mask:0xf
    v_and_b32_dpp v39, v16, v27 row_newbcast:7 row_mask:0xf bank_mask:0xf
    s_waitcnt vmcnt(9)
    v_mfma_f32_16x16x32_bf16 v[40:43], v[32:35], v[128:131], v[40:43]
    v_and_b32_dpp v32, v16, v24 row_newbcast:8 row_mask:0xf bank_mask:0xf
    v_and_b32_dpp v33, v16, v25 row_newbcast:8 row_mask:0xf bank_mask:0xf
    v_and_b32_dpp v34, v16, v26 row_newbcast:8 row_mask:0xf bank_mask:0xf
    v_and_b32_dpp v35, v16, v27 row_newbcast:8 row_mask:0xf bank_mask:0xf
    s_waitcnt vmcnt(8)
    v_mfma_f32_16x16x32_bf16 v[40:43], v[36:39], v[132:135], v[40:43]
    v_and_b32_dpp v36, v16, v24 row_newbcast:9 row_mask:0xf bank_mask:0xf
    v_and_b32_dpp v37, v16, v25 row_newbcast:9 row_mask:0xf bank_mask:0xf
    v_and_b32_dpp v38, v16, v26 row_newbcast:9 row_mask:0xf bank_mask:0xf
    v_and_b32_dpp v39, v16, v27 row_newbcast:9 row_mask:0xf bank_mask:0xf
    s_waitcnt vmcnt(7)
    v_mfma_f32_16x16x32_bf16 v[40:43], v[32:35], v[136:139], v[40:43]
    v_and_b32_dpp v32, v16, v24 row_newbcast:10 row_mask:0xf bank_mask:0xf
    v_and_b32_dpp v33, v16, v25 row_newbcast:10 row_mask:0xf bank_mask:0xf
    v_and_b32_dpp v34, v16, v26 row_newbcast:10 row_mask:0xf bank_mask:0xf
    v_and_b32_dpp v35, v16, v27 row_newbcast:10 row_mask:0xf bank_mask:0xf
    s_waitcnt vmcnt(6)
    v_mfma_f32_16x16x32_bf16 v[40:43], v[36:39], v[140:143], v[40:43]
    v_and_b32_dpp v36, v16, v24 row_newbcast:11 row_mask:0xf bank_mask:0xf
    v_and_b32_dpp v37, v16, v25 row_newbcast:11 row_mask:0xf bank_mask:0xf
    v_and_b32_dpp v38, v16, v26 row_newbcast:11 row_mask:0xf bank_mask:0xf
    v_and_b32_dpp v39, v16, v27 row_newbcast:11 row_mask:0xf bank_mask:0xf
    s_waitcnt vmcnt(5)
    v_mfma_f32_16x16x32_bf16 v[40:43], v[32:35], v[144:147], v[40:43]
    v_and_b32_dpp v32, v16, v24 row_newbcast:12 row_mask:0xf bank_mask:0xf
    v_and_b32_dpp v33, v16, v25 row_newbcast:12 row_mask:0xf bank_mask:0xf
    v_and_b32_dpp v34, v16, v26 row_newbcast:12 row_mask:0xf bank_mask:0xf
    v_and_b32_dpp v35, v16, v27 row_newbcast:12 row_mask:0xf bank_mask:0xf
    s_waitcnt vmcnt(4)
    v_mfma_f32_16x16x32_bf16 v[40:43], v[36:39], v[148:151], v[40:43]
    v_and_b32_dpp v36, v16, v24 row_newbcast:13 row_mask:0xf bank_mask:0xf
    v_and_b32_dpp v37, v16, v25 row_newbcast:13 row_mask:0xf bank_mask:0xf
    v_and_b32_dpp v38, v16, v26 row_newbcast:13 row_mask:0xf bank_mask:0xf
    v_and_b32_dpp v39, v16, v27 row_newbcast:13 row_mask:0xf bank_mask:0xf
    s_waitcnt vmcnt(3)
    v_mfma_f32_16x16x32_bf16 v[40:43], v[32:35], v[152:155], v[40:43]
    v_and_b32_dpp v32, v16, v24 row_newbcast:14 row_mask:0xf bank_mask:0xf
    v_and_b32_dpp v33, v16, v25 row_newbcast:14 row_mask:0xf bank_mask:0xf
    v_and_b32_dpp v34, v16, v26 row_newbcast:14 row_mask:0xf bank_mask:0xf
    v_and_b32_dpp v35, v16, v27 row_newbcast:14 row_mask:0xf bank_mask:0xf
    s_waitcnt vmcnt(2)
    v_mfma_f32_16x16x32_bf16 v[40:43], v[36:39], v[156:159], v[40:43]
    v_and_b32_dpp v36, v16, v24 row_newbcast:15 row_mask:0xf bank_mask:0xf
    v_and_b32_dpp v37, v16, v25 row_newbcast:15 row_mask:0xf bank_mask:0xf
    v_and_b32_dpp v38, v16, v26 row_newbcast:15 row_mask:0xf bank_mask:0xf
    v_and_b32_dpp v39, v16, v27 row_newbcast:15 row_mask:0xf bank_mask:0xf
    s_waitcnt vmcnt(1)
    v_mfma_f32_16x16x32_bf16 v[40:43], v[32:35], v[160:163], v[40:43]
    s_waitcnt vmcnt(0)
    v_mfma_f32_16x16x32_bf16 v[40:43], v[36:39], v[164:167], v[40:43]
    s_nop 7
    v_add_u32 v40, s27, v40
    v_add_u32 v41, s27, v41
    v_add_u32 v42, s27, v42
    v_add_u32 v43, s27, v43
    v_bfi_b32 v40, 15, s26, v40
    v_bfi_b32 v41, 15, s26, v41
    v_bfi_b32 v42, 15, s26, v42
    v_bfi_b32 v43, 15, s26, v43
    s_mov_b64 exec, 0xffffffff
    s_cmp_eq_u32 s34, 1
    s_cbranch_scc1 L_job_fast
    buffer_store_dwordx4 v[40:43], v31, s[20:23], 0 offen sc1
    s_branch L_job_done
L_job_fast:
    buffer_store_dwordx4 v[40:43], v31, s[20:23], 0 offen
L_job_done:
    s_mov_b64 exec, -1
    s_mov_b32 s8, s40
    s_mov_b32 s9, s41
    s_mov_b32 s10, 0x2000000
    s_mov_b32 s11, 0x20000
    s_setprio 0
    s_mov_b32 s97, 4
    s_movk_i32 s35, 4096
    s_and_b32 s7, s3, 3
    s_lshl_b32 s7, s7, 10
    s_add_u32 s7, s7, s96
    v_lshl_add_u32 v2, v0, 4, s7
    s_mov_b32 s29, 0
    s_mov_b64 vcc, 0
    s_branch L_seq4
L_v36:
    s_mov_b32 s20, s60
    s_mov_b32 s21, s61
    s_mov_b32 s22, 0x200000
    s_mov_b32 s23, 0x20000
    v_and_b32 v13, 15, v0
    v_and_b32 v14, 1, v0
    v_mov_b32 v15, 0xffff
    v_lshlrev_b32 v14, 4, v14
    v_lshlrev_b32 v15, v14, v15
    v_lshrrev_b32 v13, 1, v13
    v_cmp_eq_u32 vcc, 0, v13
    s_nop 1
    v_cndmask_b32 v24, 0, v15, vcc
    v_cmp_eq_u32 vcc, 1, v13
    s_nop 1
    v_cndmask_b32 v25, 0, v15, vcc
    v_cmp_eq_u32 vcc, 2, v13
    s_nop 1
    v_cndmask_b32 v26, 0, v15, vcc
    v_cmp_eq_u32 vcc, 3, v13
    s_nop 1
    v_cndmask_b32 v27, 0, v15, vcc
    s_and_b32 s98, s3, 3
    v_mov_b32 v8, 0
    s_mul_i32 s29, s98, 3072
    s_add_u32 s29, s29, 1024
    v_lshl_add_u32 v9, v0, 4, s29
    s_lshl_b32 s29, s98, 9
    s_add_u32 s29, s29, 13312
    v_lshlrev_b32 v10, 5, v4
    v_lshl_add_u32 v10, v3, 4, v10
    v_add_u32 v10, s29, v10
    s_barrier
    ds_read_b128 v[12:15], v9
    ds_read_b128 v[16:19], v9 offset:1024
    ds_read_b128 v[20:23], v9 offset:2048
    ds_read_b32 v7, v8 offset:4
    s_waitcnt lgkmcnt(0)
    v_and_b32 v9, 31, v0
    v_lshlrev_b32 v9, 4, v9
    v_readfirstlane_b32 s34, v7
    s_lshl_b32 s29, s6, 9
    s_add_u32 s29, s29, 262144
    v_add_u32 v11, s29, v9
    v_and_b32_dpp v32, v12, v24 row_newbcast:0 row_mask:0xf bank_mask:0xf
    v_and_b32_dpp v33, v12, v25 row_newbcast:0 row_mask:0xf bank_mask:0xf
    v_and_b32_dpp v34, v12, v26 row_newbcast:0 row_mask:0xf bank_mask:0xf
    v_and_b32_dpp v35, v12, v27 row_newbcast:0 row_mask:0xf bank_mask:0xf
    v_and_b32_dpp v36, v12, v24 row_newbcast:4 row_mask:0xf bank_mask:0xf
    v_and_b32_dpp v37, v12, v25 row_newbcast:4 row_mask:0xf bank_mask:0xf
    v_and_b32_dpp v38, v12, v26 row_newbcast:4 row_mask:0xf bank_mask:0xf
    v_and_b32_dpp v39, v12, v27 row_newbcast:4 row_mask:0xf bank_mask:0xf
    s_waitcnt vmcnt(35)
    v_mfma_f32_16x16x32_bf16 v[40:43], v[32:35], v[104:107], 0
    v_and_b32_dpp v32, v12, v24 row_newbcast:8 row_mask:0xf bank_mask:0xf
    v_and_b32_dpp v33, v12, v25 row_newbcast:8 row_mask:0xf bank_mask:0xf
    v_and_b32_dpp v34, v12, v26 row_newbcast:8 row_mask:0xf bank_mask:0xf
    v_and_b32_dpp v35, v12, v27 row_newbcast:8 row_mask:0xf bank_mask:0xf
    s_waitcnt vmcnt(34)
    v_mfma_f32_16x16x32_bf16 v[40:43], v[36:39], v[108:111], v[40:43]
    v_and_b32_dpp v36, v12, v24 row_newbcast:12 row_mask:0xf bank_mask:0xf
    v_and_b32_dpp v37, v12, v25 row_newbcast:12 row_mask:0xf bank_mask:0xf
    v_and_b32_dpp v38, v12, v26 row_newbcast:12 row_mask:0xf bank_mask:0xf
    v_and_b32_dpp v39, v12, v27 row_newbcast:12 row_mask:0xf bank_mask:0xf
    s_waitcnt vmcnt(33)
    v_mfma_f32_16x16x32_bf16 v[40:43], v[32:35], v[112:115], v[40:43]
    v_and_b32_dpp v32, v13, v24 row_newbcast:0 row_mask:0xf bank_mask:0xf
    v_and_b32_dpp v33, v13, v25 row_newbcast:0 row_mask:0xf bank_mask:0xf
    v_and_b32_dpp v34, v13, v26 row_newbcast:0 row_mask:0xf bank_mask:0xf
    v_and_b32_dpp v35, v13, v27 row_newbcast:0 row_mask:0xf bank_mask:0xf
    s_waitcnt vmcnt(32)
    v_mfma_f32_16x16x32_bf16 v[40:43], v[36:39], v[116:119], v[40:43]
    v_and_b32_dpp v36, v13, v24 row_newbcast:4 row_mask:0xf bank_mask:0xf
    v_and_b32_dpp v37, v13, v25 row_newbcast:4 row_mask:0xf bank_mask:0xf
    v_and_b32_dpp v38, v13, v26 row_newbcast:4 row_mask:0xf bank_mask:0xf
    v_and_b32_dpp v39, v13, v27 row_newbcast:4 row_mask:0xf bank_mask:0xf
    s_waitcnt vmcnt(31)
    v_mfma_f32_16x16x32_bf16 v[40:43], v[32:35], v[120:123], v[40:43]
    v_and_b32_dpp v32, v13, v24 row_newbcast:8 row_mask:0xf bank_mask:0xf
    v_and_b32_dpp v33, v13, v25 row_newbcast:8 row_mask:0xf bank_mask:0xf
    v_and_b32_dpp v34, v13, v26 row_newbcast:8 row_mask:0xf bank_mask:0xf
    v_and_b32_dpp v35, v13, v27 row_newbcast:8 row_mask:0xf bank_mask:0xf
    s_waitcnt vmcnt(30)
    v_mfma_f32_16x16x32_bf16 v[40:43], v[36:39], v[124:127], v[40:43]
    v_and_b32_dpp v36, v13, v24 row_newbcast:12 row_mask:0xf bank_mask:0xf
    v_and_b32_dpp v37, v13, v25 row_newbcast:12 row_mask:0xf bank_mask:0xf
    v_and_b32_dpp v38, v13, v26 row_newbcast:12 row_mask:0xf bank_mask:0xf
    v_and_b32_dpp v39, v13, v27 row_newbcast:12 row_mask:0xf bank_mask:0xf
    s_waitcnt vmcnt(29)
    v_mfma_f32_16x16x32_bf16 v[40:43], v[32:35], v[128:131], v[40:43]
    v_and_b32_dpp v32, v14, v24 row_newbcast:0 row_mask:0xf bank_mask:0xf
    v_and_b32_dpp v33, v14, v25 row_newbcast:0 row_mask:0xf bank_mask:0xf
    v_and_b32_dpp v34, v14, v26 row_newbcast:0 row_mask:0xf bank_mask:0xf
    v_and_b32_dpp v35, v14, v27 row_newbcast:0 row_mask:0xf bank_mask:0xf
    s_waitcnt vmcnt(28)
    v_mfma_f32_16x16x32_bf16 v[40:43], v[36:39], v[132:135], v[40:43]
    v_and_b32_dpp v36, v14, v24 row_newbcast:4 row_mask:0xf bank_mask:0xf
    v_and_b32_dpp v37, v14, v25 row_newbcast:4 row_mask:0xf bank_mask:0xf
    v_and_b32_dpp v38, v14, v26 row_newbcast:4 row_mask:0xf bank_mask:0xf
    v_and_b32_dpp v39, v14, v27 row_newbcast:4 row_mask:0xf bank_mask:0xf
    s_waitcnt vmcnt(27)
    v_mfma_f32_16x16x32_bf16 v[40:43], v[32:35], v[136:139], v[40:43]
    v_and_b32_dpp v32, v14, v24 row_newbcast:8 row_mask:0xf bank_mask:0xf
    v_and_b32_dpp v33, v14, v25 row_newbcast:8 row_mask:0xf bank_mask:0xf
    v_and_b32_dpp v34, v14, v26 row_newbcast:8 row_mask:0xf bank_mask:0xf
    v_and_b32_dpp v35, v14, v27 row_newbcast:8 row_mask:0xf bank_mask:0xf
    s_waitcnt vmcnt(26)
    v_mfma_f32_16x16x32_bf16 v[40:43], v[36:39], v[140:143], v[40:43]
    v_and_b32_dpp v36, v14, v24 row_newbcast:12 row_mask:0xf bank_mask:0xf
    v_and_b32_dpp v37, v14, v25 row_newbcast:12 row_mask:0xf bank_mask:0xf
    v_and_b32_dpp v38, v14, v26 row_newbcast:12 row_mask:0xf bank_mask:0xf
    v_and_b32_dpp v39, v14, v27 row_newbcast:12 row_mask:0xf bank_mask:0xf
    s_waitcnt vmcnt(25)
    v_mfma_f32_16x16x32_bf16 v[40:43], v[32:35], v[144:147], v[40:43]
    v_and_b32_dpp v32, v15, v24 row_newbcast:0 row_mask:0xf bank_mask:0xf
    v_and_b32_dpp v33, v15, v25 row_newbcast:0 row_mask:0xf bank_mask:0xf
    v_and_b32_dpp v34, v15, v26 row_newbcast:0 row_mask:0xf bank_mask:0xf
    v_and_b32_dpp v35, v15, v27 row_newbcast:0 row_mask:0xf bank_mask:0xf
    s_waitcnt vmcnt(24)
    v_mfma_f32_16x16x32_bf16 v[40:43], v[36:39], v[148:151], v[40:43]
    v_and_b32_dpp v36, v15, v24 row_newbcast:4 row_mask:0xf bank_mask:0xf
    v_and_b32_dpp v37, v15, v25 row_newbcast:4 row_mask:0xf bank_mask:0xf
    v_and_b32_dpp v38, v15, v26 row_newbcast:4 row_mask:0xf bank_mask:0xf
    v_and_b32_dpp v39, v15, v27 row_newbcast:4 row_mask:0xf bank_mask:0xf
    s_waitcnt vmcnt(23)
    v_mfma_f32_16x16x32_bf16 v[40:43], v[32:35], v[152:155], v[40:43]
    v_and_b32_dpp v32, v15, v24 row_newbcast:8 row_mask:0xf bank_mask:0xf
    v_and_b32_dpp v33, v15, v25 row_newbcast:8 row_mask:0xf bank_mask:0xf
    v_and_b32_dpp v34, v15, v26 row_newbcast:8 row_mask:0xf bank_mask:0xf
    v_and_b32_dpp v35, v15, v27 row_newbcast:8 row_mask:0xf bank_mask:0xf
    s_waitcnt vmcnt(22)
    v_mfma_f32_16x16x32_bf16 v[40:43], v[36:39], v[156:159], v[40:43]
    v_and_b32_dpp v36, v15, v24 row_newbcast:12 row_mask:0xf bank_mask:0xf
    v_and_b32_dpp v37, v15, v25 row_newbcast:12 row_mask:0xf bank_mask:0xf
    v_and_b32_dpp v38, v15, v26 row_newbcast:12 row_mask:0xf bank_mask:0xf
    v_and_b32_dpp v39, v15, v27 row_newbcast:12 row_mask:0xf bank_mask:0xf
    s_waitcnt vmcnt(21)
    v_mfma_f32_16x16x32_bf16 v[40:43], v[32:35], v[160:163], v[40:43]
    v_and_b32_dpp v32, v16, v24 row_newbcast:0 row_mask:0xf bank_mask:0xf
    v_and_b32_dpp v33, v16, v25 row_newbcast:0 row_mask:0xf bank_mask:0xf
    v_and_b32_dpp v34, v16, v26 row_newbcast:0 row_mask:0xf bank_mask:0xf
    v_and_b32_dpp v35, v16, v27 row_newbcast:0 row_mask:0xf bank_mask:0xf
    s_waitcnt vmcnt(20)
    v_mfma_f32_16x16x32_bf16 v[40:43], v[36:39], v[164:167], v[40:43]
    v_and_b32_dpp v36, v16, v24 row_newbcast:4 row_mask:0xf bank_mask:0xf
    v_and_b32_dpp v37, v16, v25 row_newbcast:4 row_mask:0xf bank_mask:0xf
    v_and_b32_dpp v38, v16, v26 row_newbcast:4 row_mask:0xf bank_mask:0xf
    v_and_b32_dpp v39, v16, v27 row_newbcast:4 row_mask:0xf bank_mask:0xf
    s_waitcnt vmcnt(19)
    v_mfma_f32_16x16x32_bf16 v[40:43], v[32:35], v[168:171], v[40:43]
    v_and_b32_dpp v32, v16, v24 row_newbcast:8 row_mask:0xf bank_mask:0xf
    v_and_b32_dpp v33, v16, v25 row_newbcast:8 row_mask:0xf bank_mask:0xf
    v_and_b32_dpp v34, v16, v26 row_newbcast:8 row_mask:0xf bank_mask:0xf
    v_and_b32_dpp v35, v16, v27 row_newbcast:8 row_mask:0xf bank_mask:0xf
    s_waitcnt vmcnt(18)
    v_mfma_f32_16x16x32_bf16 v[40:43], v[36:39], v[172:175], v[40:43]
    v_and_b32_dpp v36, v16, v24 row_newbcast:12 row_mask:0xf bank_mask:0xf
    v_and_b32_dpp v37, v16, v25 row_newbcast:12 row_mask:0xf bank_mask:0xf
    v_and_b32_dpp v38, v16, v26 row_newbcast:12 row_mask:0xf bank_mask:0xf
    v_and_b32_dpp v39, v16, v27 row_newbcast:12 row_mask:0xf bank_mask:0xf
    s_waitcnt vmcnt(17)
    v_mfma_f32_16x16x32_bf16 v[40:43], v[32:35], v[176:179], v[40:43]
    v_and_b32_dpp v32, v17, v24 row_newbcast:0 row_mask:0xf bank_mask:0xf
    v_and_b32_dpp v33, v17, v25 row_newbcast:0 row_mask:0xf bank_mask:0xf
    v_and_b32_dpp v34, v17, v26 row_newbcast:0 row_mask:0xf bank_mask:0xf
    v_and_b32_dpp v35, v17, v27 row_newbcast:0 row_mask:0xf bank_mask:0xf
    s_waitcnt vmcnt(16)
    v_mfma_f32_16x16x32_bf16 v[40:43], v[36:39], v[180:183], v[40:43]
    v_and_b32_dpp v36, v17, v24 row_newbcast:4 row_mask:0xf bank_mask:0xf
    v_and_b32_dpp v37, v17, v25 row_newbcast:4 row_mask:0xf bank_mask:0xf
    v_and_b32_dpp v38, v17, v26 row_newbcast:4 row_mask:0xf bank_mask:0xf
    v_and_b32_dpp v39, v17, v27 row_newbcast:4 row_mask:0xf bank_mask:0xf
    s_waitcnt vmcnt(15)
    v_mfma_f32_16x16x32_bf16 v[40:43], v[32:35], v[184:187], v[40:43]
    v_and_b32_dpp v32, v17, v24 row_newbcast:8 row_mask:0xf bank_mask:0xf
    v_and_b32_dpp v33, v17, v25 row_newbcast:8 row_mask:0xf bank_mask:0xf
    v_and_b32_dpp v34, v17, v26 row_newbcast:8 row_mask:0xf bank_mask:0xf
    v_and_b32_dpp v35, v17, v27 row_newbcast:8 row_mask:0xf bank_mask:0xf
    s_waitcnt vmcnt(14)
    v_mfma_f32_16x16x32_bf16 v[40:43], v[36:39], v[188:191], v[40:43]
    v_and_b32_dpp v36, v17, v24 row_newbcast:12 row_mask:0xf bank_mask:0xf
    v_and_b32_dpp v37, v17, v25 row_newbcast:12 row_mask:0xf bank_mask:0xf
    v_and_b32_dpp v38, v17, v26 row_newbcast:12 row_mask:0xf bank_mask:0xf
    v_and_b32_dpp v39, v17, v27 row_newbcast:12 row_mask:0xf bank_mask:0xf
    s_waitcnt vmcnt(13)
    v_mfma_f32_16x16x32_bf16 v[40:43], v[32:35], v[192:195], v[40:43]
    v_and_b32_dpp v32, v18, v24 row_newbcast:0 row_mask:0xf bank_mask:0xf
    v_and_b32_dpp v33, v18, v25 row_newbcast:0 row_mask:0xf bank_mask:0xf
    v_and_b32_dpp v34, v18, v26 row_newbcast:0 row_mask:0xf bank_mask:0xf
    v_and_b32_dpp v35, v18, v27 row_newbcast:0 row_mask:0xf bank_mask:0xf
    s_waitcnt vmcnt(12)
    v_mfma_f32_16x16x32_bf16 v[40:43], v[36:39], v[196:199], v[40:43]
    v_and_b32_dpp v36, v18, v24 row_newbcast:4 row_mask:0xf bank_mask:0xf
    v_and_b32_dpp v37, v18, v25 row_newbcast:4 row_mask:0xf bank_mask:0xf
    v_and_b32_dpp v38, v18, v26 row_newbcast:4 row_mask:0xf bank_mask:0xf
    v_and_b32_dpp v39, v18, v27 row_newbcast:4 row_mask:0xf bank_mask:0xf
    s_waitcnt vmcnt(11)
    v_mfma_f32_16x16x32_bf16 v[40:43], v[32:35], v[200:203], v[40:43]
    v_and_b32_dpp v32, v18, v24 row_newbcast:8 row_mask:0xf bank_mask:0xf
    v_and_b32_dpp v33, v18, v25 row_newbcast:8 row_mask:0xf bank_mask:0xf
    v_and_b32_dpp v34, v18, v26 row_newbcast:8 row_mask:0xf bank_mask:0xf
    v_and_b32_dpp v35, v18, v27 row_newbcast:8 row_mask:0xf bank_mask:0xf
    s_waitcnt vmcnt(10)
    v_mfma_f32_16x16x32_bf16 v[40:43], v[36:39], v[204:207], v[40:43]
    v_and_b32_dpp v36, v18, v24 row_newbcast:12 row_mask:0xf bank_mask:0xf
    v_and_b32_dpp v37, v18, v25 row_newbcast:12 row_mask:0xf bank_mask:0xf
    v_and_b32_dpp v38, v18, v26 row_newbcast:12 row_mask:0xf bank_mask:0xf
    v_and_b32_dpp v39, v18, v27 row_newbcast:12 row_mask:0xf bank_mask:0xf
    s_waitcnt vmcnt(9)
    v_mfma_f32_16x16x32_bf16 v[40:43], v[32:35], v[208:211], v[40:43]
    v_and_b32_dpp v32, v19, v24 row_newbcast:0 row_mask:0xf bank_mask:0xf
    v_and_b32_dpp v33, v19, v25 row_newbcast:0 row_mask:0xf bank_mask:0xf
    v_and_b32_dpp v34, v19, v26 row_newbcast:0 row_mask:0xf bank_mask:0xf
    v_and_b32_dpp v35, v19, v27 row_newbcast:0 row_mask:0xf bank_mask:0xf
    s_waitcnt vmcnt(8)
    v_mfma_f32_16x16x32_bf16 v[40:43], v[36:39], v[212:215], v[40:43]
    v_and_b32_dpp v36, v19, v24 row_newbcast:4 row_mask:0xf bank_mask:0xf
    v_and_b32_dpp v37, v19, v25 row_newbcast:4 row_mask:0xf bank_mask:0xf
    v_and_b32_dpp v38, v19, v26 row_newbcast:4 row_mask:0xf bank_mask:0xf
    v_and_b32_dpp v39, v19, v27 row_newbcast:4 row_mask:0xf bank_mask:0xf
    s_waitcnt vmcnt(7)
    v_mfma_f32_16x16x32_bf16 v[40:43], v[32:35], v[216:219], v[40:43]
    v_and_b32_dpp v32, v19, v24 row_newbcast:8 row_mask:0xf bank_mask:0xf
    v_and_b32_dpp v33, v19, v25 row_newbcast:8 row_mask:0xf bank_mask:0xf
    v_and_b32_dpp v34, v19, v26 row_newbcast:8 row_mask:0xf bank_mask:0xf
    v_and_b32_dpp v35, v19, v27 row_newbcast:8 row_mask:0xf bank_mask:0xf
    s_waitcnt vmcnt(6)
    v_mfma_f32_16x16x32_bf16 v[40:43], v[36:39], v[220:223], v[40:43]
    v_and_b32_dpp v36, v19, v24 row_newbcast:12 row_mask:0xf bank_mask:0xf
    v_and_b32_dpp v37, v19, v25 row_newbcast:12 row_mask:0xf bank_mask:0xf
    v_and_b32_dpp v38, v19, v26 row_newbcast:12 row_mask:0xf bank_mask:0xf
    v_and_b32_dpp v39, v19, v27 row_newbcast:12 row_mask:0xf bank_mask:0xf
    s_waitcnt vmcnt(5)
    v_mfma_f32_16x16x32_bf16 v[40:43], v[32:35], v[224:227], v[40:43]
    v_and_b32_dpp v32, v20, v24 row_newbcast:0 row_mask:0xf bank_mask:0xf
    v_and_b32_dpp v33, v20, v25 row_newbcast:0 row_mask:0xf bank_mask:0xf
    v_and_b32_dpp v34, v20, v26 row_newbcast:0 row_mask:0xf bank_mask:0xf
    v_and_b32_dpp v35, v20, v27 row_newbcast:0 row_mask:0xf bank_mask:0xf
    s_waitcnt vmcnt(4)
    v_mfma_f32_16x16x32_bf16 v[40:43], v[36:39], v[228:231], v[40:43]
    v_and_b32_dpp v36, v20, v24 row_newbcast:4 row_mask:0xf bank_mask:0xf
    v_and_b32_dpp v37, v20, v25 row_newbcast:4 row_mask:0xf bank_mask:0xf
    v_and_b32_dpp v38, v20, v26 row_newbcast:4 row_mask:0xf bank_mask:0xf
    v_and_b32_dpp v39, v20, v27 row_newbcast:4 row_mask:0xf bank_mask:0xf
    s_waitcnt vmcnt(3)
    v_mfma_f32_16x16x32_bf16 v[40:43], v[32:35], v[232:235], v[40:43]
    v_and_b32_dpp v32, v20, v24 row_newbcast:8 row_mask:0xf bank_mask:0xf
    v_and_b32_dpp v33, v20, v25 row_newbcast:8 row_mask:0xf bank_mask:0xf
    v_and_b32_dpp v34, v20, v26 row_newbcast:8 row_mask:0xf bank_mask:0xf
    v_and_b32_dpp v35, v20, v27 row_newbcast:8 row_mask:0xf bank_mask:0xf
    s_waitcnt vmcnt(2)
    v_mfma_f32_16x16x32_bf16 v[40:43], v[36:39], v[236:239], v[40:43]
    v_and_b32_dpp v36, v20, v24 row_newbcast:12 row_mask:0xf bank_mask:0xf
    v_and_b32_dpp v37, v20, v25 row_newbcast:12 row_mask:0xf bank_mask:0xf
    v_and_b32_dpp v38, v20, v26 row_newbcast:12 row_mask:0xf bank_mask:0xf
    v_and_b32_dpp v39, v20, v27 row_newbcast:12 row_mask:0xf bank_mask:0xf
    s_waitcnt vmcnt(1)
    v_mfma_f32_16x16x32_bf16 v[40:43], v[32:35], v[240:243], v[40:43]
    s_waitcnt vmcnt(0)
    v_mfma_f32_16x16x32_bf16 v[40:43], v[36:39], v[244:247], v[40:43]
    s_cmp_ge_u32 s32, 4
    s_cbranch_scc1 L_pvdone
    v_and_b32_dpp v32, v21, v24 row_newbcast:0 row_mask:0xf bank_mask:0xf
    v_and_b32_dpp v33, v21, v25 row_newbcast:0 row_mask:0xf bank_mask:0xf
    v_and_b32_dpp v34, v21, v26 row_newbcast:0 row_mask:0xf bank_mask:0xf
    v_and_b32_dpp v35, v21, v27 row_newbcast:0 row_mask:0xf bank_mask:0xf
    s_nop 1
    v_mfma_f32_16x16x32_bf16 v[40:43], v[32:35], v[248:251], v[40:43]
L_pvdone:
    s_mov_b64 exec, 0xffffffff
    s_nop 7
    ds_write_b128 v10, v[40:43]
    s_mov_b64 exec, -1
    s_waitcnt lgkmcnt(0)
    s_barrier
    s_cmp_lg_u32 s3, 4
    s_cbranch_scc1 L_exit
    ds_read_b128 v[16:19], v9 offset:13312
    ds_read_b128 v[20:23], v9 offset:13824
    ds_read_b128 v[24:27], v9 offset:14336
    ds_read_b128 v[28:31], v9 offset:14848
    s_waitcnt lgkmcnt(2)
    v_pk_add_f32 v[16:17], v[16:17], v[20:21]
    v_pk_add_f32 v[18:19], v[18:19], v[22:23]
    s_waitcnt lgkmcnt(0)
    v_pk_add_f32 v[24:25], v[24:25], v[28:29]
    v_pk_add_f32 v[26:27], v[26:27], v[30:31]
    v_pk_add_f32 v[16:17], v[16:17], v[24:25]
    v_pk_add_f32 v[18:19], v[18:19], v[26:27]
    v_bfi_b32 v16, 15, s26, v16
    v_bfi_b32 v17, 15, s26, v17
    v_bfi_b32 v18, 15, s26, v18
    v_bfi_b32 v19, 15, s26, v19
    s_mov_b64 exec, 0xffffffff
    s_cmp_eq_u32 s34, 1
    s_cbranch_scc1 L_o_fast
    buffer_store_dwordx4 v[16:19], v11, s[20:23], 0 offen sc1
    s_branch L_o_done
L_o_fast:
    buffer_store_dwordx4 v[16:19], v11, s[20:23], 0 offen
L_o_done:
    s_branch L_exit
L_SP:
    s_mov_b32 s20, s60
    s_mov_b32 s21, s61
    s_mov_b32 s22, 0x200000
    s_mov_b32 s23, 0x20000
    v_and_b32 v13, 15, v0
    v_and_b32 v14, 1, v0
    v_mov_b32 v15, 0xffff
    v_lshlrev_b32 v14, 4, v14
    v_lshlrev_b32 v15, v14, v15
    v_lshrrev_b32 v13, 1, v13
    v_cmp_eq_u32 vcc, 0, v13
    s_nop 1
    v_cndmask_b32 v24, 0, v15, vcc
    v_cmp_eq_u32 vcc, 1, v13
    s_nop 1
    v_cndmask_b32 v25, 0, v15, vcc
    v_cmp_eq_u32 vcc, 2, v13
    s_nop 1
    v_cndmask_b32 v26, 0, v15, vcc
    v_cmp_eq_u32 vcc, 3, v13
    s_nop 1
    v_cndmask_b32 v27, 0, v15, vcc
    s_mov_b32 s66, -1
    s_mov_b32 s67, 0
    v_lshlrev_b32 v5, 10, v3
    v_lshl_add_u32 v5, v4, 4, v5
    s_waitcnt lgkmcnt(0)
    s_add_u32 s24, s24, 1
    s_and_b32 s25, s24, 0xffff
    s_and_b32 s26, s24, 15
    s_mov_b32 s27, 8
    s_mov_b32 s28, 0xffff0000
    s_cmp_ge_u32 s101, 29
    s_cbranch_scc1 L_sp_f1done
    s_mul_i32 s7, s101, 6
    v_and_b32 v7, 7, v4
    v_add_u32 v7, s7, v7
    v_min_u32 v7, 171, v7
    v_lshlrev_b32 v7, 4, v7
    s_lshl_b32 s7, s3, 6
    v_add_u32 v8, s7, v3
    v_mul_u32_u24 v8, 2752, v8
    v_add_u32 v7, v7, v8
    v_mov_b32 v8, s48
    v_mov_b32 v9, s49
    v_mov_b32 v10, s50
    v_mov_b32 v11, s51
    v_cmp_gt_u32 vcc, 8, v4
    s_nop 1
    v_cndmask_b32 v8, v10, v8, vcc
    v_cndmask_b32 v9, v11, v9, vcc
    v_add_co_u32 v8, vcc, v8, v7
    s_nop 1
    v_addc_co_u32 v9, vcc, 0, v9, vcc
    s_mov_b32 s62, 0x3f3f3f3f
    s_mov_b32 s63, 0x3f3f3f3f
    s_mov_b64 exec, s[62:63]
    global_load_dwordx4 v[168:171], v[8:9], off
    v_add_co_u32 v8, vcc, 11008, v8
    s_nop 1
    v_addc_co_u32 v9, vcc, 0, v9, vcc
    global_load_dwordx4 v[172:175], v[8:9], off
    v_add_co_u32 v8, vcc, 11008, v8
    s_nop 1
    v_addc_co_u32 v9, vcc, 0, v9, vcc
    global_load_dwordx4 v[176:179], v[8:9], off
    v_add_co_u32 v8, vcc, 11008, v8
    s_nop 1
    v_addc_co_u32 v9, vcc, 0, v9, vcc
    global_load_dwordx4 v[180:183], v[8:9], off
    v_add_co_u32 v8, vcc, 11008, v8
    s_nop 1
    v_addc_co_u32 v9, vcc, 0, v9, vcc
    global_load_dwordx4 v[184:187], v[8:9], off
    v_add_co_u32 v8, vcc, 11008, v8
    s_nop 1
    v_addc_co_u32 v9, vcc, 0, v9, vcc
    global_load_dwordx4 v[188:191], v[8:9], off
    v_add_co_u32 v8, vcc, 11008, v8
    s_nop 1
    v_addc_co_u32 v9, vcc, 0, v9, vcc
    global_load_dwordx4 v[192:195], v[8:9], off
    v_add_co_u32 v8, vcc, 11008, v8
    s_nop 1
    v_addc_co_u32 v9, vcc, 0, v9, vcc
    global_load_dwordx4 v[196:199], v[8:9], off
    v_add_co_u32 v8, vcc, 11008, v8
    s_nop 1
    v_addc_co_u32 v9, vcc, 0, v9, vcc
    global_load_dwordx4 v[200:203], v[8:9], off
    v_add_co_u32 v8, vcc, 11008, v8
    s_nop 1
    v_addc_co_u32 v9, vcc, 0, v9, vcc
    global_load_dwordx4 v[204:207], v[8:9], off
    v_add_co_u32 v8, vcc, 11008, v8
    s_nop 1
    v_addc_co_u32 v9, vcc, 0, v9, vcc
    global_load_dwordx4 v[208:211], v[8:9], off
    v_add_co_u32 v8, vcc, 11008, v8
    s_nop 1
    v_addc_co_u32 v9, vcc, 0, v9, vcc
    global_load_dwordx4 v[212:215], v[8:9], off
    v_add_co_u32 v8, vcc, 11008, v8
    s_nop 1
    v_addc_co_u32 v9, vcc, 0, v9, vcc
    global_load_dwordx4 v[216:219], v[8:9], off
    v_add_co_u32 v8, vcc, 11008, v8
    s_nop 1
    v_addc_co_u32 v9, vcc, 0, v9, vcc
    global_load_dwordx4 v[220:223], v[8:9], off
    v_add_co_u32 v8, vcc, 11008, v8
    s_nop 1
    v_addc_co_u32 v9, vcc, 0, v9, vcc
    global_load_dwordx4 v[224:227], v[8:9], off
    v_add_co_u32 v8, vcc, 11008, v8
    s_nop 1
    v_addc_co_u32 v9, vcc, 0, v9, vcc
    global_load_dwordx4 v[228:231], v[8:9], off
    s_mov_b64 exec, -1
L_sp_f1done:
    s_cmp_lg_u32 s3, 7
    s_cbranch_scc1 L_sp_norm2
    s_lshl_b32 s7, s101, 8
    s_lshr_b32 s29, s101, 1
    s_lshl_b32 s29, s29, 12
    s_and_b32 s35, s101, 1
    s_lshl_b32 s35, s35, 8
    s_add_u32 s29, s29, s35
    s_add_u32 s29, s29, 65536
    v_lshlrev_b32 v7, 9, v3
    v_lshl_add_u32 v7, v4, 4, v7
    v_add_u32 v7, s29, v7
    s_add_u32 s7, s7, 36864
    v_lshl_add_u32 v8, v6, 2, s7
    s_mov_b32 s33, 0
L_poll11:
    buffer_load_dwordx4 v[40:43], v7, s[20:23], 0 offen sc1
    buffer_load_dwordx4 v[44:47], v7, s[20:23], 0 offen offset:2048 sc1
    s_add_u32 s33, s33, 1
    s_cmp_gt_u32 s33, 200000
    s_cbranch_scc1 L_exit
    s_waitcnt vmcnt(0)
    v_xor_b32 v40, s26, v40
    v_xor_b32 v41, s26, v41
    v_xor_b32 v42, s26, v42
    v_xor_b32 v43, s26, v43
    v_xor_b32 v44, s26, v44
    v_xor_b32 v45, s26, v45
    v_xor_b32 v46, s26, v46
    v_xor_b32 v47, s26, v47
    v_or3_b32 v48, v40, v41, v42
    v_or3_b32 v49, v43, v44, v45
    v_or3_b32 v48, v48, v46, v47
    v_or_b32 v48, v48, v49
    v_and_b32 v48, 0xf, v48
    v_cmp_ne_u32 vcc, 0, v48
    s_nop 0
    s_cbranch_vccz L_got12
    s_sleep 16
    s_branch L_poll11
L_got12:
    v_pk_add_f32 v[40:41], v[40:41], v[44:45]
    v_pk_add_f32 v[42:43], v[42:43], v[46:47]
    s_nop 1
    v_permlane32_swap_b32 v40, v42
    v_permlane32_swap_b32 v41, v43
    v_add_f32 v40, v40, v42
    v_add_f32 v41, v41, v43
    s_nop 1
    v_permlane16_swap_b32 v40, v41
    v_add_f32 v40, v40, v41
    v_cvt_pk_bf16_f32 v40, v40, v40
    v_lshlrev_b32 v40, 16, v40
    v_or_b32 v40, s25, v40
    buffer_store_dword v40, v8, s[20:23], 0 offen sc1
    s_setprio 0
L_sp_norm2:
    s_mov_b32 s12, s36
    s_mov_b32 s13, s37
    s_mov_b32 s14, 0x400
    s_mov_b32 s15, 0x20000
    s_lshl_b32 s7, s3, 6
    v_add_u32 v7, s7, v6
    v_lshlrev_b32 v8, 1, v7
    v_lshlrev_b32 v30, 2, v7
    v_add_u32 v30, 36864, v30
    v_and_b32 v10, 3, v0
    v_lshl_add_u32 v21, v10, 2, v3
    s_lshl_b32 s7, s101, 6
    s_add_u32 s7, s7, 43008
    v_lshl_add_u32 v31, v21, 2, s7
    s_movk_i32 s99, 4096
    buffer_load_ushort v16, v8, s[12:15], 0 offen
    s_mov_b32 s12, s52
    s_mov_b32 s13, s53
    s_mov_b32 s14, 0x158000
    s_mov_b32 s15, 0x20000
    s_mul_i32 s7, s101, 49152
    s_and_b32 s29, s3, 3
    s_lshl_b32 s29, s29, 8
    s_add_u32 s7, s7, s29
    v_add_u32 v29, s7, v5
L_sp_noffn:
    v_min_u32 v12, 2, v3
    s_lshr_b32 s7, s3, 1
    s_lshl_b32 s7, s7, 12
    s_and_b32 s29, s3, 1
    s_lshl_b32 s29, s29, 8
    s_add_u32 s7, s7, s29
    s_lshl_b32 s29, s4, 14
    s_add_u32 s7, s7, s29
    s_add_u32 s7, s7, 262144
    v_lshlrev_b32 v13, 4, v4
    v_lshl_add_u32 v7, v3, 9, v13
    v_add_u32 v7, s7, v7
    v_lshl_add_u32 v12, v12, 9, v13
    s_add_u32 s7, s7, 2048
    v_add_u32 v12, s7, v12
    s_mov_b32 s64, -1
    s_mov_b32 s65, 0xffff
    s_lshl_b32 s7, s3, 9
    v_lshlrev_b32 v8, 5, v4
    v_lshl_add_u32 v8, v3, 4, v8
    v_add_u32 v8, s7, v8
    v_and_b32 v14, 31, v0
    v_lshrrev_b32 v15, 5, v0
    v_lshlrev_b32 v9, 11, v15
    v_lshl_add_u32 v9, v14, 4, v9
    s_lshl_b32 s7, s3, 14
    s_lshl_b32 s29, s4, 11
    s_add_u32 s7, s7, s29
    s_lshl_b32 s29, s100, 9
    s_add_u32 s7, s7, s29
    s_add_u32 s7, s7, 393216
    v_lshlrev_b32 v10, 3, v15
    v_lshl_add_u32 v10, v14, 4, v10
    v_add_u32 v10, s7, v10
    s_lshl_b32 s7, s4, 14
    s_lshl_b32 s29, s3, 8
    s_add_u32 s7, s7, s29
    s_add_u32 s7, s7, 393216
    v_lshl_add_u32 v11, v3, 11, v13
    v_add_u32 v11, s7, v11
    s_movk_i32 s35, 8192
    s_lshl_b32 s7, s3, 2
    v_and_b32 v22, 1, v3
    v_lshl_add_u32 v22, v22, 5, s7
    v_lshlrev_b32 v23, 2, v4
    s_lshr_b32 s7, s3, 1
    s_lshl_b32 s29, s4, 2
    s_add_u32 s7, s7, s29
    s_lshl_b32 s7, s7, 10
    s_add_u32 s7, s7, 655360
    v_lshl_add_u32 v52, v3, 7, s7
    v_min_u32 v55, 2, v3
    s_add_u32 s7, s7, 512
    v_lshl_add_u32 v55, v55, 7, s7
    s_mov_b32 s33, 0
    s_branch L_poll13_in
L_poll13:
    s_sleep 16
L_poll13_in:
    buffer_load_dwordx4 v[40:43], v52, s[20:23], 0 offen sc1
    buffer_load_dwordx4 v[44:47], v55, s[20:23], 0 offen sc1
    buffer_load_dword v17, v30, s[20:23], 0 offen sc1
    buffer_load_dword v18, v30, s[20:23], 0 offen offset:2048 sc1
    buffer_load_dword v19, v30, s[20:23], s99 offen sc1
    buffer_load_dword v20, v31, s[20:23], 0 offen sc1
    s_add_u32 s33, s33, 1
    s_cmp_gt_u32 s33, 200000
    s_cbranch_scc1 L_exit
    s_waitcnt vmcnt(0)
    v_xor_b32 v48, s25, v17
    v_bitop3_b32 v48, v48, v18, s25 bitop3:0xf6
    v_bitop3_b32 v48, v48, v19, s25 bitop3:0xf6
    v_bitop3_b32 v48, v48, v20, s25 bitop3:0xf6
    v_and_b32 v48, 0xffff, v48
    v_cmp_ne_u32 vcc, 0, v48
    s_nop 0
    s_cbranch_vccnz L_poll13
L_poll14:
    v_xor_b32 v48, s25, v40
    v_bitop3_b32 v48, v48, v44, s25 bitop3:0xf6
    v_and_b32 v48, 0xffff, v48
    v_bitop3_b32 v48, v48, v42, s24 bitop3:0xf6
    v_bitop3_b32 v48, v48, v46, s24 bitop3:0xf6
    v_cmp_ne_u32 vcc, 0, v48
    s_nop 0
    s_cbranch_vccz L_mlok
    s_sleep 12
    buffer_load_dwordx4 v[40:43], v52, s[20:23], 0 offen sc1
    buffer_load_dwordx4 v[44:47], v55, s[20:23], 0 offen sc1
    s_add_u32 s33, s33, 1
    s_cmp_gt_u32 s33, 200000
    s_cbranch_scc1 L_exit
    s_waitcnt vmcnt(0)
    s_branch L_poll14
L_mlok:
    v_and_b32 v40, s28, v40
    v_and_b32 v44, s28, v44
    v_cndmask_b32 v45, 0, v45, s[64:65]
    v_max_f32 v48, v40, v44
    s_mov_b32 s7, 0x3fb8aa3b
    v_mov_b32 v53, v48
    s_nop 1
    v_permlane16_swap_b32 v48, v53
    v_max_f32 v48, v48, v53
    v_mov_b32 v53, v48
    s_nop 1
    v_permlane32_swap_b32 v48, v53
    v_max_f32 v48, v48, v53
    v_sub_f32 v40, v40, v48
    v_sub_f32 v44, v44, v48
    v_mul_f32 v40, s7, v40
    v_mul_f32 v44, s7, v44
    v_exp_f32 v49, v40
    v_exp_f32 v50, v44
    v_mul_f32 v51, v49, v41
    v_fmac_f32 v51, v50, v45
    v_cndmask_b32 v50, 0, v50, s[64:65]
    v_mov_b32 v53, v51
    s_nop 1
    v_permlane16_swap_b32 v51, v53
    v_add_f32 v51, v51, v53
    v_mov_b32 v53, v51
    s_nop 1
    v_permlane32_swap_b32 v51, v53
    v_add_f32 v51, v51, v53
    v_rcp_f32 v51, v51
    s_nop 0
    v_mul_f32 v49, v49, v51
    v_mul_f32 v50, v50, v51
    v_lshlrev_b32 v16, 16, v16
    v_and_b32 v17, s28, v17
    v_and_b32 v18, s28, v18
    v_and_b32 v19, s28, v19
    v_and_b32 v20, s28, v20
    v_add_f32 v19, 1.0, v19
    v_cvt_pk_bf16_f32 v19, v19, v19
    v_lshlrev_b32 v19, 16, v19
    s_mov_b32 s33, 0
L_poll15:
    buffer_load_dwordx4 v[40:43], v7, s[20:23], 0 offen sc1
    buffer_load_dwordx4 v[44:47], v12, s[20:23], 0 offen sc1
    s_add_u32 s33, s33, 1
    s_cmp_gt_u32 s33, 200000
    s_cbranch_scc1 L_exit
    s_waitcnt vmcnt(0)
    v_xor_b32 v40, s26, v40
    v_xor_b32 v41, s26, v41
    v_xor_b32 v42, s26, v42
    v_xor_b32 v43, s26, v43
    v_xor_b32 v44, s26, v44
    v_xor_b32 v45, s26, v45
    v_xor_b32 v46, s26, v46
    v_xor_b32 v47, s26, v47
    v_or3_b32 v52, v40, v41, v42
    v_or3_b32 v53, v43, v44, v45
    v_or3_b32 v52, v52, v46, v47
    v_or_b32 v52, v52, v53
    v_and_b32 v52, 0xf, v52
    v_cmp_ne_u32 vcc, 0, v52
    s_nop 0
    s_cbranch_vccnz L_poll15
    v_mul_f32 v40, v49, v40
    v_mul_f32 v41, v49, v41
    v_mul_f32 v42, v49, v42
    v_mul_f32 v43, v49, v43
    v_fmac_f32 v40, v50, v44
    v_fmac_f32 v41, v50, v45
    v_fmac_f32 v42, v50, v46
    v_fmac_f32 v43, v50, v47
    s_nop 0
    v_permlane32_swap_b32 v40, v42
    v_permlane32_swap_b32 v41, v43
    v_add_f32 v40, v40, v42
    v_add_f32 v41, v41, v43
    s_nop 1
    v_permlane16_swap_b32 v40, v41
    v_add_f32 v40, v40, v41
    v_cvt_pk_bf16_f32 v40, v40, v40
    s_nop 1
    v_and_b32_dpp v32, v40, v24 row_newbcast:0 row_mask:0xf bank_mask:0xf
    v_and_b32_dpp v33, v40, v25 row_newbcast:0 row_mask:0xf bank_mask:0xf
    v_and_b32_dpp v34, v40, v26 row_newbcast:0 row_mask:0xf bank_mask:0xf
    v_and_b32_dpp v35, v40, v27 row_newbcast:0 row_mask:0xf bank_mask:0xf
    v_and_b32_dpp v36, v40, v24 row_newbcast:1 row_mask:0xf bank_mask:0xf
    v_and_b32_dpp v37, v40, v25 row_newbcast:1 row_mask:0xf bank_mask:0xf
    v_and_b32_dpp v38, v40, v26 row_newbcast:1 row_mask:0xf bank_mask:0xf
    v_and_b32_dpp v39, v40, v27 row_newbcast:1 row_mask:0xf bank_mask:0xf
    v_mfma_f32_16x16x32_bf16 v[44:47], v[32:35], v[104:107], 0
    v_and_b32_dpp v32, v40, v24 row_newbcast:2 row_mask:0xf bank_mask:0xf
    v_and_b32_dpp v33, v40, v25 row_newbcast:2 row_mask:0xf bank_mask:0xf
    v_and_b32_dpp v34, v40, v26 row_newbcast:2 row_mask:0xf bank_mask:0xf
    v_and_b32_dpp v35, v40, v27 row_newbcast:2 row_mask:0xf bank_mask:0xf
    v_mfma_f32_16x16x32_bf16 v[44:47], v[36:39], v[108:111], v[44:47]
    v_and_b32_dpp v36, v40, v24 row_newbcast:3 row_mask:0xf bank_mask:0xf
    v_and_b32_dpp v37, v40, v25 row_newbcast:3 row_mask:0xf bank_mask:0xf
    v_and_b32_dpp v38, v40, v26 row_newbcast:3 row_mask:0xf bank_mask:0xf
    v_and_b32_dpp v39, v40, v27 row_newbcast:3 row_mask:0xf bank_mask:0xf
    v_mfma_f32_16x16x32_bf16 v[44:47], v[32:35], v[112:115], v[44:47]
    v_and_b32_dpp v32, v40, v24 row_newbcast:4 row_mask:0xf bank_mask:0xf
    v_and_b32_dpp v33, v40, v25 row_newbcast:4 row_mask:0xf bank_mask:0xf
    v_and_b32_dpp v34, v40, v26 row_newbcast:4 row_mask:0xf bank_mask:0xf
    v_and_b32_dpp v35, v40, v27 row_newbcast:4 row_mask:0xf bank_mask:0xf
    v_mfma_f32_16x16x32_bf16 v[44:47], v[36:39], v[116:119], v[44:47]
    v_and_b32_dpp v36, v40, v24 row_newbcast:5 row_mask:0xf bank_mask:0xf
    v_and_b32_dpp v37, v40, v25 row_newbcast:5 row_mask:0xf bank_mask:0xf
    v_and_b32_dpp v38, v40, v26 row_newbcast:5 row_mask:0xf bank_mask:0xf
    v_and_b32_dpp v39, v40, v27 row_newbcast:5 row_mask:0xf bank_mask:0xf
    v_mfma_f32_16x16x32_bf16 v[44:47], v[32:35], v[120:123], v[44:47]
    v_and_b32_dpp v32, v40, v24 row_newbcast:6 row_mask:0xf bank_mask:0xf
    v_and_b32_dpp v33, v40, v25 row_newbcast:6 row_mask:0xf bank_mask:0xf
    v_and_b32_dpp v34, v40, v26 row_newbcast:6 row_mask:0xf bank_mask:0xf
    v_and_b32_dpp v35, v40, v27 row_newbcast:6 row_mask:0xf bank_mask:0xf
    v_mfma_f32_16x16x32_bf16 v[44:47], v[36:39], v[124:127], v[44:47]
    v_and_b32_dpp v36, v40, v24 row_newbcast:7 row_mask:0xf bank_mask:0xf
    v_and_b32_dpp v37, v40, v25 row_newbcast:7 row_mask:0xf bank_mask:0xf
    v_and_b32_dpp v38, v40, v26 row_newbcast:7 row_mask:0xf bank_mask:0xf
    v_and_b32_dpp v39, v40, v27 row_newbcast:7 row_mask:0xf bank_mask:0xf
    v_mfma_f32_16x16x32_bf16 v[44:47], v[32:35], v[128:131], v[44:47]
    v_and_b32_dpp v32, v40, v24 row_newbcast:8 row_mask:0xf bank_mask:0xf
    v_and_b32_dpp v33, v40, v25 row_newbcast:8 row_mask:0xf bank_mask:0xf
    v_and_b32_dpp v34, v40, v26 row_newbcast:8 row_mask:0xf bank_mask:0xf
    v_and_b32_dpp v35, v40, v27 row_newbcast:8 row_mask:0xf bank_mask:0xf
    v_mfma_f32_16x16x32_bf16 v[44:47], v[36:39], v[132:135], v[44:47]
    v_and_b32_dpp v36, v40, v24 row_newbcast:9 row_mask:0xf bank_mask:0xf
    v_and_b32_dpp v37, v40, v25 row_newbcast:9 row_mask:0xf bank_mask:0xf
    v_and_b32_dpp v38, v40, v26 row_newbcast:9 row_mask:0xf bank_mask:0xf
    v_and_b32_dpp v39, v40, v27 row_newbcast:9 row_mask:0xf bank_mask:0xf
    v_mfma_f32_16x16x32_bf16 v[44:47], v[32:35], v[136:139], v[44:47]
    v_and_b32_dpp v32, v40, v24 row_newbcast:10 row_mask:0xf bank_mask:0xf
    v_and_b32_dpp v33, v40, v25 row_newbcast:10 row_mask:0xf bank_mask:0xf
    v_and_b32_dpp v34, v40, v26 row_newbcast:10 row_mask:0xf bank_mask:0xf
    v_and_b32_dpp v35, v40, v27 row_newbcast:10 row_mask:0xf bank_mask:0xf
    v_mfma_f32_16x16x32_bf16 v[44:47], v[36:39], v[140:143], v[44:47]
    v_and_b32_dpp v36, v40, v24 row_newbcast:11 row_mask:0xf bank_mask:0xf
    v_and_b32_dpp v37, v40, v25 row_newbcast:11 row_mask:0xf bank_mask:0xf
    v_and_b32_dpp v38, v40, v26 row_newbcast:11 row_mask:0xf bank_mask:0xf
    v_and_b32_dpp v39, v40, v27 row_newbcast:11 row_mask:0xf bank_mask:0xf
    v_mfma_f32_16x16x32_bf16 v[44:47], v[32:35], v[144:147], v[44:47]
    v_and_b32_dpp v32, v40, v24 row_newbcast:12 row_mask:0xf bank_mask:0xf
    v_and_b32_dpp v33, v40, v25 row_newbcast:12 row_mask:0xf bank_mask:0xf
    v_and_b32_dpp v34, v40, v26 row_newbcast:12 row_mask:0xf bank_mask:0xf
    v_and_b32_dpp v35, v40, v27 row_newbcast:12 row_mask:0xf bank_mask:0xf
    v_mfma_f32_16x16x32_bf16 v[44:47], v[36:39], v[148:151], v[44:47]
    v_and_b32_dpp v36, v40, v24 row_newbcast:13 row_mask:0xf bank_mask:0xf
    v_and_b32_dpp v37, v40, v25 row_newbcast:13 row_mask:0xf bank_mask:0xf
    v_and_b32_dpp v38, v40, v26 row_newbcast:13 row_mask:0xf bank_mask:0xf
    v_and_b32_dpp v39, v40, v27 row_newbcast:13 row_mask:0xf bank_mask:0xf
    v_mfma_f32_16x16x32_bf16 v[44:47], v[32:35], v[152:155], v[44:47]
    v_and_b32_dpp v32, v40, v24 row_newbcast:14 row_mask:0xf bank_mask:0xf
    v_and_b32_dpp v33, v40, v25 row_newbcast:14 row_mask:0xf bank_mask:0xf
    v_and_b32_dpp v34, v40, v26 row_newbcast:14 row_mask:0xf bank_mask:0xf
    v_and_b32_dpp v35, v40, v27 row_newbcast:14 row_mask:0xf bank_mask:0xf
    v_mfma_f32_16x16x32_bf16 v[44:47], v[36:39], v[156:159], v[44:47]
    v_and_b32_dpp v36, v40, v24 row_newbcast:15 row_mask:0xf bank_mask:0xf
    v_and_b32_dpp v37, v40, v25 row_newbcast:15 row_mask:0xf bank_mask:0xf
    v_and_b32_dpp v38, v40, v26 row_newbcast:15 row_mask:0xf bank_mask:0xf
    v_and_b32_dpp v39, v40, v27 row_newbcast:15 row_mask:0xf bank_mask:0xf
    v_mfma_f32_16x16x32_bf16 v[44:47], v[32:35], v[160:163], v[44:47]
    s_nop 0
    v_mfma_f32_16x16x32_bf16 v[44:47], v[36:39], v[164:167], v[44:47]
    s_mov_b64 exec, 0xffffffff
    s_nop 7
    ds_write_b128 v8, v[44:47] offset:13312
    s_mov_b64 exec, -1
    s_waitcnt lgkmcnt(0)
    s_barrier
    s_cmp_ge_u32 s3, 4
    s_cbranch_scc1 L_noypub
    ds_read_b128 v[40:43], v9 offset:13312
    ds_read_b128 v[44:47], v9 offset:13824
    ds_read_b128 v[48:51], v9 offset:14336
    ds_read_b128 v[52:55], v9 offset:14848
    s_mov_b32 s29, 0x10000
    s_waitcnt lgkmcnt(0)
    v_pk_add_f32 v[40:41], v[40:41], v[44:45]
    v_pk_add_f32 v[42:43], v[42:43], v[46:47]
    v_pk_add_f32 v[48:49], v[48:49], v[52:53]
    v_pk_add_f32 v[50:51], v[50:51], v[54:55]
    v_pk_add_f32 v[40:41], v[40:41], v[48:49]
    v_pk_add_f32 v[42:43], v[42:43], v[50:51]
    s_nop 1
    v_permlane32_swap_b32 v40, v42
    v_permlane32_swap_b32 v41, v43
    v_add_f32 v40, v40, v42
    v_add_f32 v41, v41, v43
    v_bfi_b32 v40, 15, s26, v40
    v_bfi_b32 v41, 15, s26, v41
    buffer_store_dwordx2 v[40:41], v10, s[20:23], 0 offen sc1
    buffer_store_dwordx2 v[40:41], v10, s[20:23], s29 offen sc1
L_noypub:
    s_waitcnt vmcnt(0)
    s_barrier
    s_mov_b32 s33, 0
L_poll16:
    buffer_load_dwordx4 v[44:47], v11, s[20:23], 0 offen sc1
    buffer_load_dwordx4 v[48:51], v11, s[20:23], s35 offen sc1
    s_add_u32 s33, s33, 1
    s_cmp_gt_u32 s33, 200000
    s_cbranch_scc1 L_exit
    s_waitcnt vmcnt(0)
    v_xor_b32 v44, s26, v44
    v_xor_b32 v45, s26, v45
    v_xor_b32 v46, s26, v46
    v_xor_b32 v47, s26, v47
    v_xor_b32 v48, s26, v48
    v_xor_b32 v49, s26, v49
    v_xor_b32 v50, s26, v50
    v_xor_b32 v51, s26, v51
    v_or3_b32 v52, v44, v45, v46
    v_or3_b32 v53, v47, v48, v49
    v_or3_b32 v52, v52, v50, v51
    v_or_b32 v52, v52, v53
    v_and_b32 v52, 0xf, v52
    v_cmp_ne_u32 vcc, 0, v52
    s_nop 0
    s_cbranch_vccnz L_poll16
    v_pk_add_f32 v[44:45], v[44:45], v[48:49]
    v_pk_add_f32 v[46:47], v[46:47], v[50:51]
    s_nop 1
    v_permlane32_swap_b32 v44, v46
    v_permlane32_swap_b32 v45, v47
    v_add_f32 v44, v44, v46
    v_add_f32 v45, v45, v47
    s_nop 1
    v_permlane16_swap_b32 v44, v45
    v_add_f32 v44, v44, v45
    v_cvt_pk_bf16_f32 v44, v44, v44
    v_lshlrev_b32 v44, 16, v44
    v_mul_f32 v44, v17, v44
    v_cvt_pk_bf16_f32 v44, v44, v44
    v_lshlrev_b32 v44, 16, v44
    v_add_f32 v44, v16, v44
    v_cvt_pk_bf16_f32 v44, v44, v44
    v_lshlrev_b32 v44, 16, v44
    v_mul_f32 v45, v44, v44
    v_mov_b32 v46, v44
    s_lshl_b32 s7, s3, 8
    v_lshl_add_u32 v48, v6, 2, s7
    ds_write_b32 v48, v44 offset:21504
    v_add_f32_dpp v46, v46, v46 quad_perm:[1,0,3,2] row_mask:0xf bank_mask:0xf
    v_add_f32_dpp v45, v45, v45 quad_perm:[1,0,3,2] row_mask:0xf bank_mask:0xf
    s_nop 0
    v_add_f32_dpp v46, v46, v46 quad_perm:[2,3,0,1] row_mask:0xf bank_mask:0xf
    v_add_f32_dpp v45, v45, v45 quad_perm:[2,3,0,1] row_mask:0xf bank_mask:0xf
    s_nop 0
    v_add_f32_dpp v46, v46, v46 row_half_mirror row_mask:0xf bank_mask:0xf
    v_add_f32_dpp v45, v45, v45 row_half_mirror row_mask:0xf bank_mask:0xf
    s_nop 0
    v_add_f32_dpp v46, v46, v46 row_mirror row_mask:0xf bank_mask:0xf
    v_add_f32_dpp v45, v45, v45 row_mirror row_mask:0xf bank_mask:0xf
    s_nop 1
    v_permlane16_swap_b32 v46, v45
    v_add_f32 v46, v46, v45
    v_mov_b32 v45, v46
    s_nop 1
    v_permlane32_swap_b32 v46, v45
    v_add_f32 v46, v46, v45
    s_mov_b64 exec, 0x10001
    ds_write_b32 v22, v46 offset:320
    s_mov_b64 exec, -1
    s_waitcnt lgkmcnt(0)
    s_barrier
    s_cmp_ge_u32 s101, 29
    s_cbranch_scc1 L_sp_final
    ds_read_b32 v50, v23 offset:320
    s_mov_b32 s29, 0x3b000000
    s_mov_b32 s7, 0x3727c5ac
    s_waitcnt lgkmcnt(0)
    v_add_f32_dpp v50, v50, v50 quad_perm:[1,0,3,2] row_mask:0xf bank_mask:0xf
    s_nop 1
    v_add_f32_dpp v50, v50, v50 quad_perm:[2,3,0,1] row_mask:0xf bank_mask:0xf
    s_nop 1
    v_add_f32_dpp v50, v50, v50 row_half_mirror row_mask:0xf bank_mask:0xf
    s_nop 1
    v_mov_b32_dpp v48, v50 row_newbcast:0 row_mask:0xf bank_mask:0xf
    v_mov_b32_dpp v49, v50 row_newbcast:8 row_mask:0xf bank_mask:0xf
    v_mul_f32 v48, s29, v48
    v_mul_f32 v49, s29, v49
    v_fma_f32 v49, -v48, v48, v49
    v_max_f32 v49, 0, v49
    v_cvt_pk_bf16_f32 v50, v48, v49
    v_lshlrev_b32 v48, 16, v50
    v_and_b32 v49, s28, v50
    v_add_f32 v49, s7, v49
    v_cvt_pk_bf16_f32 v49, v49, v49
    v_lshlrev_b32 v49, 16, v49
    v_sqrt_f32 v49, v49
    v_sub_f32 v44, v44, v48
    v_cvt_pk_bf16_f32 v49, v49, v49
    v_lshlrev_b32 v49, 16, v49
    v_cvt_pk_bf16_f32 v44, v44, v44
    v_lshlrev_b32 v44, 16, v44
    v_rcp_f32 v49, v49
    s_nop 0
    v_mul_f32 v44, v44, v49
    v_cvt_pk_bf16_f32 v44, v44, v44
    v_lshlrev_b32 v44, 16, v44
    v_mul_f32 v44, v44, v19
    v_cvt_pk_bf16_f32 v44, v44, v44
    v_lshlrev_b32 v44, 16, v44
    v_add_f32 v44, v44, v18
    v_cvt_pk_bf16_f32 v40, v44, v44
    s_nop 1
    v_and_b32_dpp v32, v40, v24 row_newbcast:0 row_mask:0xf bank_mask:0xf
    v_and_b32_dpp v33, v40, v25 row_newbcast:0 row_mask:0xf bank_mask:0xf
    v_and_b32_dpp v34, v40, v26 row_newbcast:0 row_mask:0xf bank_mask:0xf
    v_and_b32_dpp v35, v40, v27 row_newbcast:0 row_mask:0xf bank_mask:0xf
    v_and_b32_dpp v36, v40, v24 row_newbcast:1 row_mask:0xf bank_mask:0xf
    v_and_b32_dpp v37, v40, v25 row_newbcast:1 row_mask:0xf bank_mask:0xf
    v_and_b32_dpp v38, v40, v26 row_newbcast:1 row_mask:0xf bank_mask:0xf
    v_and_b32_dpp v39, v40, v27 row_newbcast:1 row_mask:0xf bank_mask:0xf
    v_mfma_f32_16x16x32_bf16 v[44:47], v[32:35], v[168:171], 0
    v_and_b32_dpp v32, v40, v24 row_newbcast:2 row_mask:0xf bank_mask:0xf
    v_and_b32_dpp v33, v40, v25 row_newbcast:2 row_mask:0xf bank_mask:0xf
    v_and_b32_dpp v34, v40, v26 row_newbcast:2 row_mask:0xf bank_mask:0xf
    v_and_b32_dpp v35, v40, v27 row_newbcast:2 row_mask:0xf bank_mask:0xf
    v_mfma_f32_16x16x32_bf16 v[44:47], v[36:39], v[172:175], v[44:47]
    v_and_b32_dpp v36, v40, v24 row_newbcast:3 row_mask:0xf bank_mask:0xf
    v_and_b32_dpp v37, v40, v25 row_newbcast:3 row_mask:0xf bank_mask:0xf
    v_and_b32_dpp v38, v40, v26 row_newbcast:3 row_mask:0xf bank_mask:0xf
    v_and_b32_dpp v39, v40, v27 row_newbcast:3 row_mask:0xf bank_mask:0xf
    v_mfma_f32_16x16x32_bf16 v[44:47], v[32:35], v[176:179], v[44:47]
    v_and_b32_dpp v32, v40, v24 row_newbcast:4 row_mask:0xf bank_mask:0xf
    v_and_b32_dpp v33, v40, v25 row_newbcast:4 row_mask:0xf bank_mask:0xf
    v_and_b32_dpp v34, v40, v26 row_newbcast:4 row_mask:0xf bank_mask:0xf
    v_and_b32_dpp v35, v40, v27 row_newbcast:4 row_mask:0xf bank_mask:0xf
    v_mfma_f32_16x16x32_bf16 v[44:47], v[36:39], v[180:183], v[44:47]
    v_and_b32_dpp v36, v40, v24 row_newbcast:5 row_mask:0xf bank_mask:0xf
    v_and_b32_dpp v37, v40, v25 row_newbcast:5 row_mask:0xf bank_mask:0xf
    v_and_b32_dpp v38, v40, v26 row_newbcast:5 row_mask:0xf bank_mask:0xf
    v_and_b32_dpp v39, v40, v27 row_newbcast:5 row_mask:0xf bank_mask:0xf
    v_mfma_f32_16x16x32_bf16 v[44:47], v[32:35], v[184:187], v[44:47]
    v_and_b32_dpp v32, v40, v24 row_newbcast:6 row_mask:0xf bank_mask:0xf
    v_and_b32_dpp v33, v40, v25 row_newbcast:6 row_mask:0xf bank_mask:0xf
    v_and_b32_dpp v34, v40, v26 row_newbcast:6 row_mask:0xf bank_mask:0xf
    v_and_b32_dpp v35, v40, v27 row_newbcast:6 row_mask:0xf bank_mask:0xf
    v_mfma_f32_16x16x32_bf16 v[44:47], v[36:39], v[188:191], v[44:47]
    v_and_b32_dpp v36, v40, v24 row_newbcast:7 row_mask:0xf bank_mask:0xf
    v_and_b32_dpp v37, v40, v25 row_newbcast:7 row_mask:0xf bank_mask:0xf
    v_and_b32_dpp v38, v40, v26 row_newbcast:7 row_mask:0xf bank_mask:0xf
    v_and_b32_dpp v39, v40, v27 row_newbcast:7 row_mask:0xf bank_mask:0xf
    v_mfma_f32_16x16x32_bf16 v[44:47], v[32:35], v[192:195], v[44:47]
    v_and_b32_dpp v32, v40, v24 row_newbcast:8 row_mask:0xf bank_mask:0xf
    v_and_b32_dpp v33, v40, v25 row_newbcast:8 row_mask:0xf bank_mask:0xf
    v_and_b32_dpp v34, v40, v26 row_newbcast:8 row_mask:0xf bank_mask:0xf
    v_and_b32_dpp v35, v40, v27 row_newbcast:8 row_mask:0xf bank_mask:0xf
    v_mfma_f32_16x16x32_bf16 v[44:47], v[36:39], v[196:199], v[44:47]
    v_and_b32_dpp v36, v40, v24 row_newbcast:9 row_mask:0xf bank_mask:0xf
    v_and_b32_dpp v37, v40, v25 row_newbcast:9 row_mask:0xf bank_mask:0xf
    v_and_b32_dpp v38, v40, v26 row_newbcast:9 row_mask:0xf bank_mask:0xf
    v_and_b32_dpp v39, v40, v27 row_newbcast:9 row_mask:0xf bank_mask:0xf
    v_mfma_f32_16x16x32_bf16 v[44:47], v[32:35], v[200:203], v[44:47]
    v_and_b32_dpp v32, v40, v24 row_newbcast:10 row_mask:0xf bank_mask:0xf
    v_and_b32_dpp v33, v40, v25 row_newbcast:10 row_mask:0xf bank_mask:0xf
    v_and_b32_dpp v34, v40, v26 row_newbcast:10 row_mask:0xf bank_mask:0xf
    v_and_b32_dpp v35, v40, v27 row_newbcast:10 row_mask:0xf bank_mask:0xf
    v_mfma_f32_16x16x32_bf16 v[44:47], v[36:39], v[204:207], v[44:47]
    v_and_b32_dpp v36, v40, v24 row_newbcast:11 row_mask:0xf bank_mask:0xf
    v_and_b32_dpp v37, v40, v25 row_newbcast:11 row_mask:0xf bank_mask:0xf
    v_and_b32_dpp v38, v40, v26 row_newbcast:11 row_mask:0xf bank_mask:0xf
    v_and_b32_dpp v39, v40, v27 row_newbcast:11 row_mask:0xf bank_mask:0xf
    v_mfma_f32_16x16x32_bf16 v[44:47], v[32:35], v[208:211], v[44:47]
    v_and_b32_dpp v32, v40, v24 row_newbcast:12 row_mask:0xf bank_mask:0xf
    v_and_b32_dpp v33, v40, v25 row_newbcast:12 row_mask:0xf bank_mask:0xf
    v_and_b32_dpp v34, v40, v26 row_newbcast:12 row_mask:0xf bank_mask:0xf
    v_and_b32_dpp v35, v40, v27 row_newbcast:12 row_mask:0xf bank_mask:0xf
    v_mfma_f32_16x16x32_bf16 v[44:47], v[36:39], v[212:215], v[44:47]
    v_and_b32_dpp v36, v40, v24 row_newbcast:13 row_mask:0xf bank_mask:0xf
    v_and_b32_dpp v37, v40, v25 row_newbcast:13 row_mask:0xf bank_mask:0xf
    v_and_b32_dpp v38, v40, v26 row_newbcast:13 row_mask:0xf bank_mask:0xf
    v_and_b32_dpp v39, v40, v27 row_newbcast:13 row_mask:0xf bank_mask:0xf
    v_mfma_f32_16x16x32_bf16 v[44:47], v[32:35], v[216:219], v[44:47]
    v_and_b32_dpp v32, v40, v24 row_newbcast:14 row_mask:0xf bank_mask:0xf
    v_and_b32_dpp v33, v40, v25 row_newbcast:14 row_mask:0xf bank_mask:0xf
    v_and_b32_dpp v34, v40, v26 row_newbcast:14 row_mask:0xf bank_mask:0xf
    v_and_b32_dpp v35, v40, v27 row_newbcast:14 row_mask:0xf bank_mask:0xf
    v_mfma_f32_16x16x32_bf16 v[44:47], v[36:39], v[220:223], v[44:47]
    v_and_b32_dpp v36, v40, v24 row_newbcast:15 row_mask:0xf bank_mask:0xf
    v_and_b32_dpp v37, v40, v25 row_newbcast:15 row_mask:0xf bank_mask:0xf
    v_and_b32_dpp v38, v40, v26 row_newbcast:15 row_mask:0xf bank_mask:0xf
    v_and_b32_dpp v39, v40, v27 row_newbcast:15 row_mask:0xf bank_mask:0xf
    v_mfma_f32_16x16x32_bf16 v[44:47], v[32:35], v[224:227], v[44:47]
    s_nop 0
    v_mfma_f32_16x16x32_bf16 v[44:47], v[36:39], v[228:231], v[44:47]
    s_cmp_ge_u32 s101, 29
    s_cbranch_scc1 L_sp_now2
    s_cmp_ge_u32 s3, 4
    s_cbranch_scc1 L_sp_now2
    s_mov_b32 s29, 0
    buffer_load_dwordx4 v[56:59], v29, s[12:15], s29 offen
    s_add_u32 s29, s29, 4096
    buffer_load_dwordx4 v[60:63], v29, s[12:15], s29 offen
    s_add_u32 s29, s29, 4096
    buffer_load_dwordx4 v[64:67], v29, s[12:15], s29 offen
    s_add_u32 s29, s29, 4096
    buffer_load_dwordx4 v[68:71], v29, s[12:15], s29 offen
    s_add_u32 s29, s29, 4096
    buffer_load_dwordx4 v[72:75], v29, s[12:15], s29 offen
    s_add_u32 s29, s29, 4096
    buffer_load_dwordx4 v[76:79], v29, s[12:15], s29 offen
    s_add_u32 s29, s29, 4096
    buffer_load_dwordx4 v[80:83], v29, s[12:15], s29 offen
    s_add_u32 s29, s29, 4096
    buffer_load_dwordx4 v[84:87], v29, s[12:15], s29 offen
    s_add_u32 s29, s29, 4096
    buffer_load_dwordx4 v[88:91], v29, s[12:15], s29 offen
    s_add_u32 s29, s29, 4096
    buffer_load_dwordx4 v[92:95], v29, s[12:15], s29 offen
    s_add_u32 s29, s29, 4096
    buffer_load_dwordx4 v[96:99], v29, s[12:15], s29 offen
    s_add_u32 s29, s29, 4096
    buffer_load_dwordx4 v[100:103], v29, s[12:15], s29 offen
L_sp_now2:
    s_mov_b64 exec, 0xffffffff
    s_nop 7
    ds_write_b128 v8, v[44:47] offset:17408
    s_mov_b64 exec, -1
    s_waitcnt lgkmcnt(0)
    s_barrier
    s_cmp_ge_u32 s3, 4
    s_cbranch_scc1 L_sp_final
    ds_read_b128 v[40:43], v9 offset:17408
    ds_read_b128 v[44:47], v9 offset:17920
    ds_read_b128 v[48:51], v9 offset:18432
    ds_read_b128 v[52:55], v9 offset:18944
    s_lshl_b32 s7, s101, 11
    s_add_u32 s7, s7, 524288
    v_add_u32 v8, s7, v8
    s_mov_b32 s7, 0xbfb8aa3b
    s_waitcnt lgkmcnt(0)
    v_pk_add_f32 v[40:41], v[40:41], v[44:45]
    v_pk_add_f32 v[42:43], v[42:43], v[46:47]
    v_pk_add_f32 v[48:49], v[48:49], v[52:53]
    v_pk_add_f32 v[50:51], v[50:51], v[54:55]
    v_pk_add_f32 v[40:41], v[40:41], v[48:49]
    v_pk_add_f32 v[42:43], v[42:43], v[50:51]
    s_nop 1
    v_permlane32_swap_b32 v40, v42
    v_permlane32_swap_b32 v41, v43
    v_add_f32 v40, v40, v42
    v_add_f32 v41, v41, v43
    s_nop 1
    v_permlane16_swap_b32 v40, v41
    v_cvt_pk_bf16_f32 v42, v40, v41
    v_lshlrev_b32 v40, 16, v42
    v_and_b32 v41, s28, v42
    v_mul_f32 v42, s7, v40
    v_exp_f32 v42, v42
    s_nop 0
    v_add_f32 v42, 1.0, v42
    v_rcp_f32 v42, v42
    s_nop 0
    v_mul_f32 v40, v40, v42
    v_cvt_pk_bf16_f32 v40, v40, v40
    v_lshlrev_b32 v40, 16, v40
    v_mul_f32 v40, v40, v41
    v_cvt_pk_bf16_f32 v40, v40, v40
    s_waitcnt vmcnt(0)
    s_nop 0
    v_and_b32_dpp v32, v40, v24 row_newbcast:0 row_mask:0xf bank_mask:0xf
    v_and_b32_dpp v33, v40, v25 row_newbcast:0 row_mask:0xf bank_mask:0xf
    v_and_b32_dpp v34, v40, v26 row_newbcast:0 row_mask:0xf bank_mask:0xf
    v_and_b32_dpp v35, v40, v27 row_newbcast:0 row_mask:0xf bank_mask:0xf
    v_and_b32_dpp v36, v40, v24 row_newbcast:1 row_mask:0xf bank_mask:0xf
    v_and_b32_dpp v37, v40, v25 row_newbcast:1 row_mask:0xf bank_mask:0xf
    v_and_b32_dpp v38, v40, v26 row_newbcast:1 row_mask:0xf bank_mask:0xf
    v_and_b32_dpp v39, v40, v27 row_newbcast:1 row_mask:0xf bank_mask:0xf
    v_mfma_f32_16x16x32_bf16 v[44:47], v[32:35], v[56:59], 0
    v_and_b32_dpp v32, v40, v24 row_newbcast:2 row_mask:0xf bank_mask:0xf
    v_and_b32_dpp v33, v40, v25 row_newbcast:2 row_mask:0xf bank_mask:0xf
    v_and_b32_dpp v34, v40, v26 row_newbcast:2 row_mask:0xf bank_mask:0xf
    v_and_b32_dpp v35, v40, v27 row_newbcast:2 row_mask:0xf bank_mask:0xf
    v_mfma_f32_16x16x32_bf16 v[44:47], v[36:39], v[60:63], v[44:47]
    v_and_b32_dpp v36, v40, v24 row_newbcast:3 row_mask:0xf bank_mask:0xf
    v_and_b32_dpp v37, v40, v25 row_newbcast:3 row_mask:0xf bank_mask:0xf
    v_and_b32_dpp v38, v40, v26 row_newbcast:3 row_mask:0xf bank_mask:0xf
    v_and_b32_dpp v39, v40, v27 row_newbcast:3 row_mask:0xf bank_mask:0xf
    v_mfma_f32_16x16x32_bf16 v[44:47], v[32:35], v[64:67], v[44:47]
    v_and_b32_dpp v32, v40, v24 row_newbcast:4 row_mask:0xf bank_mask:0xf
    v_and_b32_dpp v33, v40, v25 row_newbcast:4 row_mask:0xf bank_mask:0xf
    v_and_b32_dpp v34, v40, v26 row_newbcast:4 row_mask:0xf bank_mask:0xf
    v_and_b32_dpp v35, v40, v27 row_newbcast:4 row_mask:0xf bank_mask:0xf
    v_mfma_f32_16x16x32_bf16 v[44:47], v[36:39], v[68:71], v[44:47]
    v_and_b32_dpp v36, v40, v24 row_newbcast:5 row_mask:0xf bank_mask:0xf
    v_and_b32_dpp v37, v40, v25 row_newbcast:5 row_mask:0xf bank_mask:0xf
    v_and_b32_dpp v38, v40, v26 row_newbcast:5 row_mask:0xf bank_mask:0xf
    v_and_b32_dpp v39, v40, v27 row_newbcast:5 row_mask:0xf bank_mask:0xf
    v_mfma_f32_16x16x32_bf16 v[44:47], v[32:35], v[72:75], v[44:47]
    v_and_b32_dpp v32, v40, v24 row_newbcast:6 row_mask:0xf bank_mask:0xf
    v_and_b32_dpp v33, v40, v25 row_newbcast:6 row_mask:0xf bank_mask:0xf
    v_and_b32_dpp v34, v40, v26 row_newbcast:6 row_mask:0xf bank_mask:0xf
    v_and_b32_dpp v35, v40, v27 row_newbcast:6 row_mask:0xf bank_mask:0xf
    v_mfma_f32_16x16x32_bf16 v[44:47], v[36:39], v[76:79], v[44:47]
    v_and_b32_dpp v36, v40, v24 row_newbcast:7 row_mask:0xf bank_mask:0xf
    v_and_b32_dpp v37, v40, v25 row_newbcast:7 row_mask:0xf bank_mask:0xf
    v_and_b32_dpp v38, v40, v26 row_newbcast:7 row_mask:0xf bank_mask:0xf
    v_and_b32_dpp v39, v40, v27 row_newbcast:7 row_mask:0xf bank_mask:0xf
    v_mfma_f32_16x16x32_bf16 v[44:47], v[32:35], v[80:83], v[44:47]
    v_and_b32_dpp v32, v40, v24 row_newbcast:8 row_mask:0xf bank_mask:0xf
    v_and_b32_dpp v33, v40, v25 row_newbcast:8 row_mask:0xf bank_mask:0xf
    v_and_b32_dpp v34, v40, v26 row_newbcast:8 row_mask:0xf bank_mask:0xf
    v_and_b32_dpp v35, v40, v27 row_newbcast:8 row_mask:0xf bank_mask:0xf
    v_mfma_f32_16x16x32_bf16 v[44:47], v[36:39], v[84:87], v[44:47]
    v_and_b32_dpp v36, v40, v24 row_newbcast:9 row_mask:0xf bank_mask:0xf
    v_and_b32_dpp v37, v40, v25 row_newbcast:9 row_mask:0xf bank_mask:0xf
    v_and_b32_dpp v38, v40, v26 row_newbcast:9 row_mask:0xf bank_mask:0xf
    v_and_b32_dpp v39, v40, v27 row_newbcast:9 row_mask:0xf bank_mask:0xf
    v_mfma_f32_16x16x32_bf16 v[44:47], v[32:35], v[88:91], v[44:47]
    v_and_b32_dpp v32, v40, v24 row_newbcast:10 row_mask:0xf bank_mask:0xf
    v_and_b32_dpp v33, v40, v25 row_newbcast:10 row_mask:0xf bank_mask:0xf
    v_and_b32_dpp v34, v40, v26 row_newbcast:10 row_mask:0xf bank_mask:0xf
    v_and_b32_dpp v35, v40, v27 row_newbcast:10 row_mask:0xf bank_mask:0xf
    v_mfma_f32_16x16x32_bf16 v[44:47], v[36:39], v[92:95], v[44:47]
    v_and_b32_dpp v36, v40, v24 row_newbcast:11 row_mask:0xf bank_mask:0xf
    v_and_b32_dpp v37, v40, v25 row_newbcast:11 row_mask:0xf bank_mask:0xf
    v_and_b32_dpp v38, v40, v26 row_newbcast:11 row_mask:0xf bank_mask:0xf
    v_and_b32_dpp v39, v40, v27 row_newbcast:11 row_mask:0xf bank_mask:0xf
    v_mfma_f32_16x16x32_bf16 v[44:47], v[32:35], v[96:99], v[44:47]
    s_nop 0
    v_mfma_f32_16x16x32_bf16 v[44:47], v[36:39], v[100:103], v[44:47]
    s_nop 7
    v_bfi_b32 v44, 15, s26, v44
    v_bfi_b32 v45, 15, s26, v45
    v_bfi_b32 v46, 15, s26, v46
    v_bfi_b32 v47, 15, s26, v47
    s_mov_b64 exec, 0xffffffff
    buffer_store_dwordx4 v[44:47], v8, s[20:23], 0 offen sc1
    s_barrier
    s_branch L_exit
L_sp_final:
    s_lshl_b32 s7, s101, 3
    s_add_u32 s7, s7, s3
    s_cmp_lg_u32 s7, 7
    s_cbranch_scc1 L_noepoch
    v_mov_b32 v42, s24
    v_mov_b32 v43, 0
    s_mov_b64 exec, 1
    buffer_store_dword v42, v43, s[20:23], 0 offen
    s_mov_b64 exec, -1
L_noepoch:
    s_cmp_lg_u32 s3, 4
    s_cbranch_scc1 L_exit
    v_and_b32 v10, 3, v0
    s_lshl_b32 s7, s101, 6
    v_lshl_add_u32 v11, v10, 4, s7
    v_lshl_add_u32 v16, v21, 2, s7
    ds_read_b32 v16, v16 offset:21504
    v_lshrrev_b32 v12, 2, v0
    v_add_u32 v13, 16, v12
    v_cmp_gt_u32 s[64:65], 29, v13
    v_min_u32 v13, 28, v13
    v_add_u32 v11, 524288, v11
    v_lshl_add_u32 v12, v12, 11, v11
    v_lshl_add_u32 v13, v13, 11, v11
    s_lshl_b32 s7, s101, 5
    v_lshl_add_u32 v14, v21, 1, s7
    s_mov_b32 s12, s58
    s_mov_b32 s13, s59
    s_mov_b32 s14, 0x400
    s_mov_b32 s15, 0x20000
    s_cmp_ge_u32 s101, 29
    s_cbranch_scc1 L_nog3
    s_barrier
L_nog3:
    s_sleep 11
    s_mov_b32 s33, 0
L_poll17:
    buffer_load_dwordx4 v[40:43], v12, s[20:23], 0 offen sc1
    buffer_load_dwordx4 v[44:47], v13, s[20:23], 0 offen sc1
    s_add_u32 s33, s33, 1
    s_cmp_gt_u32 s33, 200000
    s_cbranch_scc1 L_exit
    s_waitcnt vmcnt(0)
    v_xor_b32 v40, s26, v40
    v_xor_b32 v41, s26, v41
    v_xor_b32 v42, s26, v42
    v_xor_b32 v43, s26, v43
    v_xor_b32 v44, s26, v44
    v_xor_b32 v45, s26, v45
    v_xor_b32 v46, s26, v46
    v_xor_b32 v47, s26, v47
    v_or3_b32 v48, v40, v41, v42
    v_or3_b32 v49, v43, v44, v45
    v_or3_b32 v48, v48, v46, v47
    v_or_b32 v48, v48, v49
    v_and_b32 v48, 0xf, v48
    v_cmp_ne_u32 vcc, 0, v48
    s_nop 0
    s_cbranch_vccnz L_poll17
    v_cndmask_b32 v44, 0, v44, s[64:65]
    v_cndmask_b32 v45, 0, v45, s[64:65]
    v_cndmask_b32 v46, 0, v46, s[64:65]
    v_cndmask_b32 v47, 0, v47, s[64:65]
    v_pk_add_f32 v[40:41], v[40:41], v[44:45]
    v_pk_add_f32 v[42:43], v[42:43], v[46:47]
    s_nop 1
    v_permlane32_swap_b32 v40, v42
    v_permlane32_swap_b32 v41, v43
    v_add_f32 v40, v40, v42
    v_add_f32 v41, v41, v43
    s_nop 1
    v_permlane16_swap_b32 v40, v41
    v_add_f32 v40, v40, v41
    s_nop 1
    v_add_f32_dpp v40, v40, v40 row_ror:4 row_mask:0xf bank_mask:0xf
    s_nop 1
    v_add_f32_dpp v40, v40, v40 row_ror:8 row_mask:0xf bank_mask:0xf
    s_waitcnt lgkmcnt(0)
    v_cvt_pk_bf16_f32 v40, v40, v40
    v_lshlrev_b32 v40, 16, v40
    v_mul_f32 v40, v20, v40
    v_cvt_pk_bf16_f32 v40, v40, v40
    v_lshlrev_b32 v40, 16, v40
    v_add_f32 v40, v16, v40
    v_cvt_pk_bf16_f32 v40, v40, v40
    s_mov_b32 exec_lo, 0x000f000f
    s_mov_b32 exec_hi, 0x000f000f
    buffer_store_short v40, v14, s[12:15], 0 offen
L_exit:
L_end:
    s_endpgm

.section .rodata,"a"
.p2align 6
.amdhsa_kernel adaLN_cond__mha_block_cached__glu_gated_swiglu__decode_kernel
  .amdhsa_next_free_vgpr 256
  .amdhsa_next_free_sgpr 102
  .amdhsa_accum_offset 256
  .amdhsa_group_segment_fixed_size 0
  .amdhsa_kernarg_size 112
  .amdhsa_user_sgpr_count 2
  .amdhsa_user_sgpr_kernarg_segment_ptr 1
  .amdhsa_system_sgpr_workgroup_id_x 1
  .amdhsa_float_denorm_mode_32 3
.end_amdhsa_kernel
```
